```python
import torch

def _softmax(x, axis=-1):
    return torch.softmax(x, dim=axis)
def _gelu(x):
    return torch.nn.functional.gelu(x, approximate="tanh")
def _silu(x):
    return torch.nn.functional.silu(x)
def _sigmoid(x):
    return torch.sigmoid(x)
def _layernorm(x, axis=-1, eps=1e-5):
    m = x.mean(dim=axis, keepdim=True)
    v = x.var(dim=axis, keepdim=True, unbiased=False)
    return (x - m) / torch.sqrt(v + eps)
def _scatter_add(tgt, idx, src, axis=0):
    return tgt.clone().index_add_(axis, idx, src)
def _segment_sum(src, seg, n):
    out = torch.zeros((n,) + src.shape[1:], dtype=src.dtype)
    return out.index_add_(0, seg, src)
def _pad(x, pw):
    flat = tuple(v for pair in reversed(pw) for v in pair)
    return torch.nn.functional.pad(x, flat)

kernel_name = 'gated_mix__mha_block__sliding_local_dilated__prompt'

def setup_inputs():

    _w = (lambda a: (lambda t: t.to(torch.bfloat16) if t.is_floating_point() else t)(torch.as_tensor(a)))
    def _A_setup():
        B, S, D, H = 1, 2048, 512, 32
        return {
            "x": _w((lambda *s: torch.randn(*s, dtype=torch.bfloat16) * 0.05)(B, S, D)),
            "wqkv": _w((lambda *s: torch.randn(*s, dtype=torch.bfloat16) * 1.6)(D, 3 * D)),
            "wo": _w((lambda *s: torch.randn(*s, dtype=torch.bfloat16) * 0.1)(D, D)),
        }
    _A_in = _A_setup()

    def _B_setup():
        B, S, D = 1, 2048, 512
        return {
            "x": _w((lambda *s: torch.randn(*s, dtype=torch.bfloat16) * 0.05)(B, S, D)),
            "wqkv": _w((lambda *s: torch.randn(*s, dtype=torch.bfloat16) * 1.6)(D, 3 * D)),
            "wo": _w((lambda *s: torch.randn(*s, dtype=torch.bfloat16) * 0.05)(D, D)),
        }
    _B_in = _B_setup()

    return {
        "A_x": _A_in["x"],
        "A_wqkv": _A_in["wqkv"],
        "A_wo": _A_in["wo"],
        "B_x": _B_in["x"],
        "B_wqkv": _B_in["wqkv"],
        "B_wo": _B_in["wo"],
        "gate_w": _w((lambda *s: torch.randn(*s, dtype=torch.bfloat16) * 0.05)(512) * 16.0),
    }

def reference(A_x, A_wqkv, A_wo, B_x, B_wqkv, B_wo, gate_w):
    def _A_ref(x, wqkv, wo):
        B, S, D = x.shape
        H = 32
        Dh = D // H
        qkv = (lambda x, *d: x.permute(*d))((x @ wqkv).reshape(B, S, 3, H, Dh), 2, 0, 3, 1, 4)
        q, k, v = qkv[0], qkv[1], qkv[2]
        scores = torch.einsum("bhqd,bhkd->bhqk", q, k) * (Dh ** -0.5)
        p = _softmax(scores, axis=-1)
        o = torch.einsum("bhqk,bhkd->bhqd", p, v)
        return (lambda x, *d: x.permute(*d))(o, 0, 2, 1, 3).reshape(B, S, D) @ wo

    def _B_ref(x, wqkv, wo):
        B, S, D = x.shape
        H = 32; Dh = D // H
        W, dil = 8, 2
        qkv = (lambda x, *d: x.permute(*d))((x @ wqkv).reshape(B, S, 3, H, Dh), 2, 0, 3, 1, 4)
        q, k, v = qkv[0], qkv[1], qkv[2]
        scale = Dh ** -0.5
        pos = torch.arange(S)
        off = torch.arange(W) * dil
        idx = pos[:, None] - off[None, :]
        mask = idx >= 0
        idx_c = torch.where(mask, idx, 0).reshape(-1)
        kg = k[:, :, idx_c, :].reshape(B, H, S, W, Dh)
        vg = v[:, :, idx_c, :].reshape(B, H, S, W, Dh)
        logits = torch.einsum("bhsd,bhswd->bhsw", q, kg) * scale
        logits = torch.where(mask[None, None, :, :], logits, -1e9)
        attn = _softmax(logits, axis=-1)
        o = torch.einsum("bhsw,bhswd->bhsd", attn, vg)
        return (lambda x, *d: x.permute(*d))(o, 0, 2, 1, 3).reshape(B, S, D) @ wo

    x = A_x
    g = _sigmoid((x * gate_w).sum(-1, keepdims=True))
    a = _A_ref(x, A_wqkv, A_wo)
    b = _B_ref(x, B_wqkv, B_wo)
    return g * a + (1 - g) * b
```

```asm
; @launch grid=(256,1,1) block=(512,1,1) lds=163840
.amdgcn_target "amdgcn-amd-amdhsa--gfx950"
.text
.globl gated_mix__mha_block__sliding_local_dilated__prompt_kernel
.p2align 8
.type gated_mix__mha_block__sliding_local_dilated__prompt_kernel,@function
gated_mix__mha_block__sliding_local_dilated__prompt_kernel:
    s_cmp_ge_u32 s2, 256
    s_cbranch_scc1 K_END
    s_load_dwordx4 s[4:7], s[0:1], 0
    s_load_dwordx4 s[36:39], s[0:1], 64
    s_load_dwordx4 s[12:15], s[0:1], 32
    s_load_dwordx4 s[16:19], s[0:1], 48
    s_load_dwordx2 s[8:9], s[0:1], 16
    s_memrealtime s[76:77]
    s_and_b32 s47, s2, 7
    s_lshr_b32 s48, s2, 3
    s_and_b32 s40, s47, 3
    s_lshl_b32 s40, s40, 3
    s_and_b32 s80, s48, 7
    s_add_u32 s40, s40, s80
    s_lshr_b32 s41, s47, 2
    s_lshl_b32 s41, s41, 2
    s_lshr_b32 s81, s48, 3
    s_add_u32 s41, s41, s81
    s_lshr_b32 s42, s48, 2
    s_lshl_b32 s43, s47, 2
    s_and_b32 s51, s48, 3
    s_add_u32 s43, s43, s51
    v_lshrrev_b32 v2, 6, v0
    v_and_b32 v1, 63, v0
    v_readfirstlane_b32 s63, v2
    v_lshlrev_b32 v2, 4, v1
    v_lshrrev_b32 v4, 5, v1
    v_and_b32 v5, 31, v1
    v_mov_b32 v31, 0
    s_and_b32 s44, s63, 3
    s_cmp_lt_u32 s63, 4
    s_cbranch_scc1 GEMM
    s_lshl_b32 s81, s81, 1
    s_add_u32 s82, s80, s81
    s_and_b32 s82, s82, 7
    v_lshrrev_b32 v19, 3, v1
    v_and_b32 v15, 7, v1
    v_lshrrev_b32 v16, 4, v1
    s_lshl_b32 s50, s44, 4
    s_lshl_b32 s49, s40, 6
    s_add_u32 s49, s49, s50
    v_add_u32 v12, s49, v19
    v_lshlrev_b32 v12, 10, v12
    v_xor_b32 v13, v15, v16
    v_xor_b32 v14, 4, v13
    v_lshl_add_u32 v8, v13, 4, v12
    v_lshl_add_u32 v9, v14, 4, v12
    v_add_u32 v9, 0x2000, v9
    v_add_u32 v12, s50, v19
    v_mul_u32_u24 v12, 0xc00, v12
    v_and_b32 v13, 1, v16
    v_lshlrev_b32 v13, 2, v13
    v_xor_b32 v13, v15, v13
    v_lshl_add_u32 v10, v13, 4, v12
    s_lshl_b32 s50, s41, 7
    v_add_u32 v10, s50, v10
    v_add_u32 v11, 0x6000, v10
    s_lshl_b32 s83, s44, 11
    s_lshl_b32 s80, s82, 7
    s_mul_i32 s81, s82, 0x30000
    s_mov_b32 s82, s81
    s_mov_b32 s11, s81
    s_waitcnt lgkmcnt(0)
    s_mov_b32 s20, s4
    s_mov_b32 s21, s5
    s_mov_b32 s22, 0x200000
    s_mov_b32 s23, 0x20000
    s_mov_b32 s24, s6
    s_mov_b32 s25, s7
    s_mov_b32 s26, 0x180000
    s_mov_b32 s27, 0x20000
    s_add_u32 m0, s83, 0x0
    s_nop 0
    buffer_load_dwordx4 v8, s[20:23], s80 offen lds
    s_add_u32 m0, s83, 0x400
    s_nop 0
    buffer_load_dwordx4 v9, s[20:23], s80 offen lds
    s_add_u32 s80, s80, 128
    s_and_b32 s80, s80, 0x3ff
    s_add_u32 m0, s83, 0x1c00
    s_nop 0
    buffer_load_dwordx4 v10, s[24:27], s81 offen offset:1024 lds
    s_add_u32 m0, s83, 0x2000
    s_nop 0
    buffer_load_dwordx4 v11, s[24:27], s81 offen offset:1024 lds
    s_add_u32 m0, s83, 0x3800
    s_nop 0
    buffer_load_dwordx4 v10, s[24:27], s81 offen offset:2048 lds
    s_add_u32 m0, s83, 0x3c00
    s_nop 0
    buffer_load_dwordx4 v11, s[24:27], s81 offen offset:2048 lds
    s_add_u32 s81, s81, 0x30000
    s_cmp_eq_u32 s81, 0x180000
    s_cselect_b32 s81, 0, s81
    s_mov_b32 s28, s38
    s_mov_b32 s29, s39
    s_mov_b32 s30, 0x10000000
    s_mov_b32 s31, 0x20000
    s_mov_b32 s32, s36
    s_mov_b32 s33, s37
    s_mov_b32 s34, 0x100
    s_mov_b32 s35, 0x20000
    s_mov_b32 s84, s12
    s_mov_b32 s85, s13
    s_mov_b32 s86, 0x180000
    s_mov_b32 s87, 0x20000
    s_mov_b32 s88, s16
    s_mov_b32 s89, s17
    s_mov_b32 s90, 0x400
    s_mov_b32 s91, 0x20000
    s_lshl_b32 s47, s2, 3
    s_add_u32 s47, s47, s63
    s_cmp_eq_u32 s47, 4
    s_cbranch_scc1 TAGPUB
TAGPUBD:
    s_add_u32 m0, s83, 0x6000
    s_nop 0
    buffer_load_dwordx4 v8, s[20:23], s80 offen lds
    s_add_u32 m0, s83, 0x6400
    s_nop 0
    buffer_load_dwordx4 v9, s[20:23], s80 offen lds
    s_add_u32 s80, s80, 128
    s_and_b32 s80, s80, 0x3ff
    s_add_u32 m0, s83, 0x7c00
    s_nop 0
    buffer_load_dwordx4 v10, s[24:27], s81 offen offset:1024 lds
    s_add_u32 m0, s83, 0x8000
    s_nop 0
    buffer_load_dwordx4 v11, s[24:27], s81 offen offset:1024 lds
    s_add_u32 m0, s83, 0x9800
    s_nop 0
    buffer_load_dwordx4 v10, s[24:27], s81 offen offset:2048 lds
    s_add_u32 m0, s83, 0x9c00
    s_nop 0
    buffer_load_dwordx4 v11, s[24:27], s81 offen offset:2048 lds
    s_add_u32 s81, s81, 0x30000
    s_cmp_eq_u32 s81, 0x180000
    s_cselect_b32 s81, 0, s81
    s_add_u32 m0, s83, 0x18000
    s_nop 0
    buffer_load_dwordx4 v10, s[24:27], s82 offen offset:0 lds
    s_add_u32 m0, s83, 0x18400
    s_nop 0
    buffer_load_dwordx4 v11, s[24:27], s82 offen offset:0 lds
    s_add_u32 s82, s82, 0x30000
    s_cmp_eq_u32 s82, 0x180000
    s_cselect_b32 s82, 0, s82
    s_lshl_b32 s92, s40, 6
    s_lshl_b32 s47, s41, 3
    s_add_u32 s92, s92, s47
    s_lshl_b32 s47, s44, 1
    s_add_u32 s92, s92, s47
    s_lshl_b32 s10, s92, 3
    s_add_u32 s10, s10, 0x100c000
    s_lshl_b32 s92, s92, 10
    buffer_load_dwordx4 v[40:43], v2, s[88:91], 0 offen
    v_and_b32 v3, 15, v1
    v_lshlrev_b32 v3, 4, v3
    v_lshl_add_u32 v3, v4, 8, v3
    v_and_b32 v6, 0x33, v1
    v_bfe_u32 v7, v1, 2, 1
    v_lshl_add_u32 v6, v7, 3, v6
    v_bfe_u32 v7, v1, 3, 1
    v_lshl_add_u32 v6, v7, 2, v6
    v_lshlrev_b32 v6, 4, v6
    s_lshl_b32 s45, s40, 1
    s_lshl_b32 s62, s41, 2
    s_add_u32 s62, s62, s44
    v_min_u32 v17, 31, v1
    v_lshlrev_b32 v17, 7, v17
    s_lshr_b32 s48, s62, 1
    s_lshl_b32 s48, s48, 13
    s_add_u32 s48, s48, 0x1021000
    s_lshl_b32 s52, s62, 17
    s_add_u32 s52, s52, 0x10000
    s_lshl_b32 s49, s44, 11
    s_add_u32 s49, s49, 57344
    s_mov_b32 s60, 0x0000ffff
    s_mov_b32 s61, 0x0000ffff
    v_and_b32 v30, 27, v1
    v_cmp_eq_u32 vcc, 16, v30
    v_mov_b32 v7, 0x3f803f80
    s_lshl_b32 s58, s44, 14
    v_cndmask_b32 v30, 0, v7, vcc
    v_mov_b32 v7, 0xdddddddd
    s_add_u32 s58, s58, 98304
    s_lshl_b32 s59, s44, 17
    s_lshl_b32 s51, s42, 7
    s_add_u32 s59, s59, s51
    s_mov_b32 s56, 0
    s_and_b32 s64, s63, 1
    s_lshr_b32 s65, s63, 1
    s_lshl_b32 s66, s43, 1
    s_add_u32 s66, s66, s64
    s_lshl_b32 s74, s45, 8
    s_add_u32 s74, s74, 0x100c000
    s_lshl_b32 s67, s66, 6
    s_lshl_b32 s68, s65, 3
    s_add_u32 s67, s67, s68
    s_lshl_b32 s67, s67, 10
    s_add_u32 s67, s67, 0xc00000
    s_add_u32 s70, s67, 4096
    s_add_u32 s68, s67, 0x8000
    s_add_u32 s71, s68, 4096
    s_lshl_b32 s69, s66, 4
    s_lshl_b32 s47, s65, 2
    s_add_u32 s69, s69, s47
    s_lshl_b32 s69, s69, 7
    s_add_u32 s69, s69, 0x1060000
    s_lshl_b32 s73, s45, 6
    s_add_u32 s73, s73, s62
    s_lshl_b32 s73, s73, 10
    s_add_u32 s73, s73, 0xc00000
    s_add_u32 s53, s73, 0x10000
    s_lshl_b32 s72, s66, 15
    s_add_u32 s72, s72, s51
    s_lshr_b32 s47, s65, 1
    s_lshl_b32 s47, s47, 6
    s_add_u32 s72, s72, s47
    s_and_b32 s47, s65, 1
    s_lshl_b32 s47, s47, 4
    s_add_u32 s72, s72, s47
    v_cmp_gt_u32 vcc, 32, v1
    v_mov_b32 v92, 0x3f80
    v_mov_b32 v227, v30
    v_cndmask_b32 v80, 0, v92, vcc
    v_mov_b32 v81, 0
    v_mov_b32 v82, 0
    v_mov_b32 v83, 0
    v_mov_b32 v85, 0
    v_mov_b32 v86, 0
    v_mov_b32 v87, 0
    v_mov_b32 v89, 0
    v_mov_b32 v90, 0
    v_mov_b32 v91, 0
    v_lshlrev_b32 v225, 3, v5
    v_lshrrev_b32 v226, 3, v1
    v_lshlrev_b32 v226, 10, v226
    v_bfe_u32 v92, v1, 4, 1
    v_lshlrev_b32 v92, 2, v92
    v_and_b32 v93, 7, v1
    v_xor_b32 v92, v92, v93
    v_lshl_add_u32 v226, v92, 4, v226
    v_bfe_u32 v232, v1, 2, 2
    v_lshl_add_u32 v233, v4, 2, v232
    v_lshlrev_b32 v233, 7, v233
    v_and_b32 v234, 1, v1
    v_lshlrev_b32 v234, 2, v234
    v_bfe_u32 v235, v1, 1, 1
    v_add_u32 v234, v234, v235
    v_bfe_u32 v235, v1, 4, 1
    v_lshl_add_u32 v234, v235, 1, v234
    s_and_b32 s47, s65, 1
    s_lshl_b32 s47, s47, 1
    v_xor_b32 v234, s47, v234
    v_and_b32 v235, 1, v234
    v_lshl_add_u32 v233, v235, 3, v233
    v_lshrrev_b32 v234, 1, v234
    v_bfe_u32 v235, v1, 3, 1
    s_lshr_b32 s47, s65, 1
    v_xor_b32 v235, s47, v235
    v_lshl_add_u32 v234, v235, 2, v234
    v_lshl_add_u32 v233, v234, 4, v233
    s_lshl_b32 s47, s65, 14
    v_add_u32 v232, s47, v233
    v_xor_b32 v233, 64, v232
    v_add_u32 v234, 98304, v232
    v_add_u32 v235, 98304, v233
    v_and_b32 v224, 3, v1
    v_lshlrev_b32 v224, 7, v224
    s_mul_i32 s47, s44, 5120
    s_add_u32 s47, s47, 77824
    v_add_u32 v240, s47, v2
    v_lshlrev_b32 v241, 3, v1
    v_add_u32 v241, s47, v241
    s_lshl_b32 s47, s44, 2
    s_add_u32 s47, s47, 65552
    v_mov_b32 v242, s47
    v_mov_b32 v246, 65536
    v_mov_b32 v247, 1
    v_mov_b32 v132, v30
    v_mov_b32 v133, v30
    v_mov_b32 v134, v30
    v_mov_b32 v135, v30
    v_mov_b32 v136, v30
    v_mov_b32 v137, v30
    v_mov_b32 v138, v30
    v_mov_b32 v139, v30
    v_mov_b32 v144, v30
    v_mov_b32 v145, v30
    v_mov_b32 v146, v30
    v_mov_b32 v147, v30
    v_mov_b32 v148, v30
    v_mov_b32 v149, v30
    v_mov_b32 v150, v30
    v_mov_b32 v151, v30
    v_mov_b32 v156, v30
    v_mov_b32 v157, v30
    v_mov_b32 v158, v30
    v_mov_b32 v159, v30
    v_mov_b32 v160, v30
    v_mov_b32 v161, v30
    v_mov_b32 v162, v30
    v_mov_b32 v163, v30
    v_mov_b32 v168, v30
    v_mov_b32 v169, v30
    v_mov_b32 v170, v30
    v_mov_b32 v171, v30
    v_mov_b32 v172, v30
    v_mov_b32 v173, v30
    v_mov_b32 v174, v30
    v_mov_b32 v175, v30
    v_mov_b32 v180, v30
    v_mov_b32 v181, v30
    v_mov_b32 v182, v30
    v_mov_b32 v183, v30
    v_mov_b32 v184, v30
    v_mov_b32 v185, v30
    v_mov_b32 v186, v30
    v_mov_b32 v187, v30
    v_mov_b32 v192, v30
    v_mov_b32 v193, v30
    v_mov_b32 v194, v30
    v_mov_b32 v195, v30
    v_mov_b32 v196, v30
    v_mov_b32 v197, v30
    v_mov_b32 v198, v30
    v_mov_b32 v199, v30
    v_mov_b32 v204, v30
    v_mov_b32 v205, v30
    v_mov_b32 v206, v30
    v_mov_b32 v207, v30
    v_mov_b32 v208, v30
    v_mov_b32 v209, v30
    v_mov_b32 v210, v30
    v_mov_b32 v211, v30
    v_mov_b32 v216, v30
    v_mov_b32 v217, v30
    v_mov_b32 v218, v30
    v_mov_b32 v219, v30
    v_mov_b32 v220, v30
    v_mov_b32 v221, v30
    v_mov_b32 v222, v30
    v_mov_b32 v223, v30
    s_waitcnt vmcnt(9)
    s_barrier
    s_add_u32 m0, s83, 0xc000
    s_nop 0
    buffer_load_dwordx4 v8, s[20:23], s80 offen lds
    s_add_u32 m0, s83, 0xc400
    s_nop 0
    buffer_load_dwordx4 v9, s[20:23], s80 offen lds
    s_add_u32 s80, s80, 128
    s_and_b32 s80, s80, 0x3ff
    s_add_u32 m0, s83, 0xdc00
    s_nop 0
    buffer_load_dwordx4 v10, s[24:27], s81 offen offset:1024 lds
    s_add_u32 m0, s83, 0xe000
    s_nop 0
    buffer_load_dwordx4 v11, s[24:27], s81 offen offset:1024 lds
    s_add_u32 m0, s83, 0xf800
    s_nop 0
    buffer_load_dwordx4 v10, s[24:27], s81 offen offset:2048 lds
    s_add_u32 m0, s83, 0xfc00
    s_nop 0
    buffer_load_dwordx4 v11, s[24:27], s81 offen offset:2048 lds
    s_add_u32 s81, s81, 0x30000
    s_cmp_eq_u32 s81, 0x180000
    s_cselect_b32 s81, 0, s81
    s_add_u32 m0, s83, 0x12000
    s_nop 0
    buffer_load_dwordx4 v10, s[84:87], s11 offen offset:0 lds
    s_add_u32 m0, s83, 0x12400
    s_nop 0
    buffer_load_dwordx4 v11, s[84:87], s11 offen offset:0 lds
    s_add_u32 m0, s83, 0x13c00
    s_nop 0
    buffer_load_dwordx4 v10, s[84:87], s11 offen offset:1024 lds
    s_add_u32 m0, s83, 0x14000
    s_nop 0
    buffer_load_dwordx4 v11, s[84:87], s11 offen offset:1024 lds
    s_add_u32 m0, s83, 0x15800
    s_nop 0
    buffer_load_dwordx4 v10, s[84:87], s11 offen offset:2048 lds
    s_add_u32 m0, s83, 0x15c00
    s_nop 0
    buffer_load_dwordx4 v11, s[84:87], s11 offen offset:2048 lds
    s_add_u32 s11, s11, 0x30000
    s_cmp_eq_u32 s11, 0x180000
    s_cselect_b32 s11, 0, s11
    s_waitcnt vmcnt(15)
    s_barrier
    s_add_u32 m0, s83, 0x0
    s_nop 0
    buffer_load_dwordx4 v8, s[20:23], s80 offen lds
    s_add_u32 m0, s83, 0x400
    s_nop 0
    buffer_load_dwordx4 v9, s[20:23], s80 offen lds
    s_add_u32 s80, s80, 128
    s_and_b32 s80, s80, 0x3ff
    s_add_u32 m0, s83, 0x1c00
    s_nop 0
    buffer_load_dwordx4 v10, s[24:27], s81 offen offset:1024 lds
    s_add_u32 m0, s83, 0x2000
    s_nop 0
    buffer_load_dwordx4 v11, s[24:27], s81 offen offset:1024 lds
    s_add_u32 m0, s83, 0x3800
    s_nop 0
    buffer_load_dwordx4 v10, s[24:27], s81 offen offset:2048 lds
    s_add_u32 m0, s83, 0x3c00
    s_nop 0
    buffer_load_dwordx4 v11, s[24:27], s81 offen offset:2048 lds
    s_add_u32 s81, s81, 0x30000
    s_cmp_eq_u32 s81, 0x180000
    s_cselect_b32 s81, 0, s81
    s_waitcnt vmcnt(12)
    s_barrier
    buffer_load_dwordx4 v[32:35], v2, s[20:23], s92 offen
    buffer_load_dwordx4 v[36:39], v2, s[20:23], s92 offen offset:1024
    s_add_u32 m0, s83, 0x6000
    s_nop 0
    buffer_load_dwordx4 v8, s[20:23], s80 offen lds
    s_add_u32 m0, s83, 0x6400
    s_nop 0
    buffer_load_dwordx4 v9, s[20:23], s80 offen lds
    s_add_u32 s80, s80, 128
    s_and_b32 s80, s80, 0x3ff
    s_add_u32 m0, s83, 0x7c00
    s_nop 0
    buffer_load_dwordx4 v10, s[24:27], s81 offen offset:1024 lds
    s_add_u32 m0, s83, 0x8000
    s_nop 0
    buffer_load_dwordx4 v11, s[24:27], s81 offen offset:1024 lds
    s_add_u32 m0, s83, 0x9800
    s_nop 0
    buffer_load_dwordx4 v10, s[24:27], s81 offen offset:2048 lds
    s_add_u32 m0, s83, 0x9c00
    s_nop 0
    buffer_load_dwordx4 v11, s[24:27], s81 offen offset:2048 lds
    s_add_u32 s81, s81, 0x30000
    s_cmp_eq_u32 s81, 0x180000
    s_cselect_b32 s81, 0, s81
    s_waitcnt vmcnt(8)
    s_barrier
    s_add_u32 m0, s83, 0xc000
    s_nop 0
    buffer_load_dwordx4 v8, s[20:23], s80 offen lds
    s_add_u32 m0, s83, 0xc400
    s_nop 0
    buffer_load_dwordx4 v9, s[20:23], s80 offen lds
    s_add_u32 s80, s80, 128
    s_and_b32 s80, s80, 0x3ff
    s_add_u32 m0, s83, 0xdc00
    s_nop 0
    buffer_load_dwordx4 v10, s[24:27], s81 offen offset:1024 lds
    s_add_u32 m0, s83, 0xe000
    s_nop 0
    buffer_load_dwordx4 v11, s[24:27], s81 offen offset:1024 lds
    s_add_u32 m0, s83, 0xf800
    s_nop 0
    buffer_load_dwordx4 v10, s[24:27], s81 offen offset:2048 lds
    s_add_u32 m0, s83, 0xfc00
    s_nop 0
    buffer_load_dwordx4 v11, s[24:27], s81 offen offset:2048 lds
    s_add_u32 s81, s81, 0x30000
    s_cmp_eq_u32 s81, 0x180000
    s_cselect_b32 s81, 0, s81
    s_waitcnt vmcnt(6)
    s_barrier
    s_add_u32 m0, s83, 0x0
    s_nop 0
    buffer_load_dwordx4 v8, s[20:23], s80 offen lds
    s_add_u32 m0, s83, 0x400
    s_nop 0
    buffer_load_dwordx4 v9, s[20:23], s80 offen lds
    s_add_u32 s80, s80, 128
    s_and_b32 s80, s80, 0x3ff
    s_add_u32 m0, s83, 0x1c00
    s_nop 0
    buffer_load_dwordx4 v10, s[24:27], s81 offen offset:1024 lds
    s_add_u32 m0, s83, 0x2000
    s_nop 0
    buffer_load_dwordx4 v11, s[24:27], s81 offen offset:1024 lds
    s_add_u32 m0, s83, 0x3800
    s_nop 0
    buffer_load_dwordx4 v10, s[24:27], s81 offen offset:2048 lds
    s_add_u32 m0, s83, 0x3c00
    s_nop 0
    buffer_load_dwordx4 v11, s[24:27], s81 offen offset:2048 lds
    s_add_u32 s81, s81, 0x30000
    s_cmp_eq_u32 s81, 0x180000
    s_cselect_b32 s81, 0, s81
    s_waitcnt vmcnt(6)
    s_barrier
    s_add_u32 m0, s83, 0x6000
    s_nop 0
    buffer_load_dwordx4 v8, s[20:23], s80 offen lds
    s_add_u32 m0, s83, 0x6400
    s_nop 0
    buffer_load_dwordx4 v9, s[20:23], s80 offen lds
    s_add_u32 s80, s80, 128
    s_and_b32 s80, s80, 0x3ff
    s_add_u32 m0, s83, 0x7c00
    s_nop 0
    buffer_load_dwordx4 v10, s[24:27], s81 offen offset:1024 lds
    s_add_u32 m0, s83, 0x8000
    s_nop 0
    buffer_load_dwordx4 v11, s[24:27], s81 offen offset:1024 lds
    s_add_u32 m0, s83, 0x9800
    s_nop 0
    buffer_load_dwordx4 v10, s[24:27], s81 offen offset:2048 lds
    s_add_u32 m0, s83, 0x9c00
    s_nop 0
    buffer_load_dwordx4 v11, s[24:27], s81 offen offset:2048 lds
    s_add_u32 s81, s81, 0x30000
    s_cmp_eq_u32 s81, 0x180000
    s_cselect_b32 s81, 0, s81
    s_add_u32 m0, s83, 0x1a000
    s_nop 0
    buffer_load_dwordx4 v10, s[24:27], s82 offen offset:0 lds
    s_add_u32 m0, s83, 0x1a400
    s_nop 0
    buffer_load_dwordx4 v11, s[24:27], s82 offen offset:0 lds
    s_add_u32 s82, s82, 0x30000
    s_cmp_eq_u32 s82, 0x180000
    s_cselect_b32 s82, 0, s82
    s_add_u32 m0, s83, 0x1c000
    s_nop 0
    buffer_load_dwordx4 v10, s[24:27], s82 offen offset:0 lds
    s_add_u32 m0, s83, 0x1c400
    s_nop 0
    buffer_load_dwordx4 v11, s[24:27], s82 offen offset:0 lds
    s_add_u32 s82, s82, 0x30000
    s_cmp_eq_u32 s82, 0x180000
    s_cselect_b32 s82, 0, s82
    s_waitcnt vmcnt(10)
    s_barrier
    s_add_u32 m0, s83, 0x1e000
    s_nop 0
    buffer_load_dwordx4 v10, s[24:27], s82 offen offset:0 lds
    s_add_u32 m0, s83, 0x1e400
    s_nop 0
    buffer_load_dwordx4 v11, s[24:27], s82 offen offset:0 lds
    s_add_u32 s82, s82, 0x30000
    s_cmp_eq_u32 s82, 0x180000
    s_cselect_b32 s82, 0, s82
    s_add_u32 m0, s83, 0x20000
    s_nop 0
    buffer_load_dwordx4 v10, s[24:27], s82 offen offset:0 lds
    s_add_u32 m0, s83, 0x20400
    s_nop 0
    buffer_load_dwordx4 v11, s[24:27], s82 offen offset:0 lds
    s_add_u32 s82, s82, 0x30000
    s_cmp_eq_u32 s82, 0x180000
    s_cselect_b32 s82, 0, s82
    s_add_u32 m0, s83, 0x22000
    s_nop 0
    buffer_load_dwordx4 v10, s[24:27], s82 offen offset:0 lds
    s_add_u32 m0, s83, 0x22400
    s_nop 0
    buffer_load_dwordx4 v11, s[24:27], s82 offen offset:0 lds
    s_add_u32 s82, s82, 0x30000
    s_cmp_eq_u32 s82, 0x180000
    s_cselect_b32 s82, 0, s82
    s_waitcnt vmcnt(10)
    s_barrier
    s_add_u32 m0, s83, 0x24000
    s_nop 0
    buffer_load_dwordx4 v10, s[24:27], s82 offen offset:0 lds
    s_add_u32 m0, s83, 0x24400
    s_nop 0
    buffer_load_dwordx4 v11, s[24:27], s82 offen offset:0 lds
    s_add_u32 s82, s82, 0x30000
    s_cmp_eq_u32 s82, 0x180000
    s_cselect_b32 s82, 0, s82
    s_add_u32 m0, s83, 0x26000
    s_nop 0
    buffer_load_dwordx4 v10, s[24:27], s82 offen offset:0 lds
    s_add_u32 m0, s83, 0x26400
    s_nop 0
    buffer_load_dwordx4 v11, s[24:27], s82 offen offset:0 lds
    s_add_u32 s82, s82, 0x30000
    s_cmp_eq_u32 s82, 0x180000
    s_cselect_b32 s82, 0, s82
    s_waitcnt vmcnt(0)
    s_barrier
    s_waitcnt lgkmcnt(0)
    buffer_load_dwordx2 v[58:59], v31, s[32:35], 0 offen sc1
    s_add_u32 m0, s83, 0x0
    s_nop 0
    buffer_load_dwordx4 v10, s[84:87], s11 offen offset:0 lds
    s_add_u32 m0, s83, 0x400
    s_nop 0
    buffer_load_dwordx4 v11, s[84:87], s11 offen offset:0 lds
    s_add_u32 m0, s83, 0x1c00
    s_nop 0
    buffer_load_dwordx4 v10, s[84:87], s11 offen offset:1024 lds
    s_add_u32 m0, s83, 0x2000
    s_nop 0
    buffer_load_dwordx4 v11, s[84:87], s11 offen offset:1024 lds
    s_add_u32 m0, s83, 0x3800
    s_nop 0
    buffer_load_dwordx4 v10, s[84:87], s11 offen offset:2048 lds
    s_add_u32 m0, s83, 0x3c00
    s_nop 0
    buffer_load_dwordx4 v11, s[84:87], s11 offen offset:2048 lds
    s_add_u32 s11, s11, 0x30000
    s_cmp_eq_u32 s11, 0x180000
    s_cselect_b32 s11, 0, s11
    s_add_u32 m0, s83, 0x6000
    s_nop 0
    buffer_load_dwordx4 v10, s[84:87], s11 offen offset:0 lds
    s_add_u32 m0, s83, 0x6400
    s_nop 0
    buffer_load_dwordx4 v11, s[84:87], s11 offen offset:0 lds
    s_add_u32 m0, s83, 0x7c00
    s_nop 0
    buffer_load_dwordx4 v10, s[84:87], s11 offen offset:1024 lds
    s_add_u32 m0, s83, 0x8000
    s_nop 0
    buffer_load_dwordx4 v11, s[84:87], s11 offen offset:1024 lds
    s_add_u32 m0, s83, 0x9800
    s_nop 0
    buffer_load_dwordx4 v10, s[84:87], s11 offen offset:2048 lds
    s_add_u32 m0, s83, 0x9c00
    s_nop 0
    buffer_load_dwordx4 v11, s[84:87], s11 offen offset:2048 lds
    s_add_u32 s11, s11, 0x30000
    s_cmp_eq_u32 s11, 0x180000
    s_cselect_b32 s11, 0, s11
    v_lshlrev_b32 v44, 16, v40
    v_and_b32 v45, 0xffff0000, v40
    v_lshlrev_b32 v46, 16, v41
    v_and_b32 v47, 0xffff0000, v41
    v_lshlrev_b32 v48, 16, v42
    v_and_b32 v49, 0xffff0000, v42
    v_lshlrev_b32 v50, 16, v43
    v_and_b32 v51, 0xffff0000, v43
    v_lshlrev_b32 v52, 16, v32
    v_and_b32 v53, 0xffff0000, v32
    v_mul_f32 v52, v52, v44
    v_mul_f32 v53, v53, v45
    v_cvt_pk_bf16_f32 v54, v52, v53
    v_lshlrev_b32 v52, 16, v54
    v_and_b32 v53, 0xffff0000, v54
    v_add_f32 v56, v52, v53
    v_lshlrev_b32 v52, 16, v33
    v_and_b32 v53, 0xffff0000, v33
    v_mul_f32 v52, v52, v46
    v_mul_f32 v53, v53, v47
    v_cvt_pk_bf16_f32 v54, v52, v53
    v_lshlrev_b32 v52, 16, v54
    v_and_b32 v53, 0xffff0000, v54
    v_add_f32 v56, v56, v52
    v_add_f32 v56, v56, v53
    v_lshlrev_b32 v52, 16, v34
    v_and_b32 v53, 0xffff0000, v34
    v_mul_f32 v52, v52, v48
    v_mul_f32 v53, v53, v49
    v_cvt_pk_bf16_f32 v54, v52, v53
    v_lshlrev_b32 v52, 16, v54
    v_and_b32 v53, 0xffff0000, v54
    v_add_f32 v56, v56, v52
    v_add_f32 v56, v56, v53
    v_lshlrev_b32 v52, 16, v35
    v_and_b32 v53, 0xffff0000, v35
    v_mul_f32 v52, v52, v50
    v_mul_f32 v53, v53, v51
    v_cvt_pk_bf16_f32 v54, v52, v53
    v_lshlrev_b32 v52, 16, v54
    v_and_b32 v53, 0xffff0000, v54
    v_add_f32 v56, v56, v52
    v_add_f32 v56, v56, v53
    v_lshlrev_b32 v52, 16, v36
    v_and_b32 v53, 0xffff0000, v36
    v_mul_f32 v52, v52, v44
    v_mul_f32 v53, v53, v45
    v_cvt_pk_bf16_f32 v54, v52, v53
    v_lshlrev_b32 v52, 16, v54
    v_and_b32 v53, 0xffff0000, v54
    v_add_f32 v57, v52, v53
    v_lshlrev_b32 v52, 16, v37
    v_and_b32 v53, 0xffff0000, v37
    v_mul_f32 v52, v52, v46
    v_mul_f32 v53, v53, v47
    v_cvt_pk_bf16_f32 v54, v52, v53
    v_lshlrev_b32 v52, 16, v54
    v_and_b32 v53, 0xffff0000, v54
    v_add_f32 v57, v57, v52
    v_add_f32 v57, v57, v53
    v_lshlrev_b32 v52, 16, v38
    v_and_b32 v53, 0xffff0000, v38
    v_mul_f32 v52, v52, v48
    v_mul_f32 v53, v53, v49
    v_cvt_pk_bf16_f32 v54, v52, v53
    v_lshlrev_b32 v52, 16, v54
    v_and_b32 v53, 0xffff0000, v54
    v_add_f32 v57, v57, v52
    v_add_f32 v57, v57, v53
    v_lshlrev_b32 v52, 16, v39
    v_and_b32 v53, 0xffff0000, v39
    v_mul_f32 v52, v52, v50
    v_mul_f32 v53, v53, v51
    v_cvt_pk_bf16_f32 v54, v52, v53
    v_lshlrev_b32 v52, 16, v54
    v_and_b32 v53, 0xffff0000, v54
    v_add_f32 v57, v57, v52
    v_add_f32 v57, v57, v53
    s_nop 1
    v_add_f32_dpp v56, v56, v56 quad_perm:[1,0,3,2] row_mask:0xf bank_mask:0xf
    v_add_f32_dpp v57, v57, v57 quad_perm:[1,0,3,2] row_mask:0xf bank_mask:0xf
    s_nop 1
    v_add_f32_dpp v56, v56, v56 quad_perm:[2,3,0,1] row_mask:0xf bank_mask:0xf
    v_add_f32_dpp v57, v57, v57 quad_perm:[2,3,0,1] row_mask:0xf bank_mask:0xf
    s_nop 1
    v_add_f32_dpp v56, v56, v56 row_half_mirror row_mask:0xf bank_mask:0xf
    v_add_f32_dpp v57, v57, v57 row_half_mirror row_mask:0xf bank_mask:0xf
    s_nop 1
    v_add_f32_dpp v56, v56, v56 row_mirror row_mask:0xf bank_mask:0xf
    v_add_f32_dpp v57, v57, v57 row_mirror row_mask:0xf bank_mask:0xf
    s_nop 1
    v_readlane_b32 s88, v56, 0
    v_readlane_b32 s89, v56, 16
    v_readlane_b32 s90, v56, 32
    v_readlane_b32 s91, v56, 48
    v_readlane_b32 s92, v57, 0
    v_readlane_b32 s93, v57, 16
    v_readlane_b32 s94, v57, 32
    v_readlane_b32 s95, v57, 48
    s_nop 1
    v_cmp_eq_u32 vcc, 0, v1
    v_mov_b32 v52, s88
    v_add_f32 v52, s89, v52
    v_add_f32 v52, s90, v52
    v_add_f32 v52, s91, v52
    v_mov_b32 v53, s92
    v_add_f32 v53, s93, v53
    v_add_f32 v53, s94, v53
    v_add_f32 v53, s95, v53
    v_cndmask_b32 v52, v53, v52, vcc
    v_cvt_pk_bf16_f32 v52, v52, v52
    v_and_b32 v52, 0xffff0000, v52
    v_mul_f32 v52, 0xbfb8aa3b, v52
    v_exp_f32 v52, v52
    s_nop 0
    v_add_f32 v52, 1.0, v52
    v_rcp_f32 v52, v52
    s_nop 0
    v_cvt_pk_bf16_f32 v52, v52, v52
    v_and_b32 v52, 0xffff0000, v52
    v_sub_f32 v53, 1.0, v52
    v_cvt_pk_bf16_f32 v236, v53, v52
    v_lshlrev_b32 v238, 3, v1
    s_mov_b64 s[94:95], 0
    s_waitcnt vmcnt(12)
    v_readfirstlane_b32 s76, v58
    v_readfirstlane_b32 s77, v59
    s_nop 1
    s_cmp_eq_u32 s76, 0
    s_cbranch_scc1 TAG1_S
TAGD1:
    v_mov_b32 v20, v10
    v_mov_b32 v21, v11
    s_barrier
    v_add_u32 v18, s49, v2
    ds_read_b128 v[8:11], v18 offset:0
    ds_read_b128 v[12:15], v18 offset:1024
    s_add_u32 m0, s83, 0x18000
    s_nop 0
    buffer_load_dwordx4 v20, s[84:87], s11 offen offset:0 lds
    s_add_u32 m0, s83, 0x18400
    s_nop 0
    buffer_load_dwordx4 v21, s[84:87], s11 offen offset:0 lds
    s_add_u32 m0, s83, 0x19c00
    s_nop 0
    buffer_load_dwordx4 v20, s[84:87], s11 offen offset:1024 lds
    s_add_u32 m0, s83, 0x1a000
    s_nop 0
    buffer_load_dwordx4 v21, s[84:87], s11 offen offset:1024 lds
    s_add_u32 m0, s83, 0x1b800
    s_nop 0
    buffer_load_dwordx4 v20, s[84:87], s11 offen offset:2048 lds
    s_add_u32 m0, s83, 0x1bc00
    s_nop 0
    buffer_load_dwordx4 v21, s[84:87], s11 offen offset:2048 lds
    s_add_u32 s11, s11, 0x30000
    s_cmp_eq_u32 s11, 0x180000
    s_cselect_b32 s11, 0, s11
    s_waitcnt vmcnt(12)
    s_barrier
    s_add_u32 m0, s83, 0x1e000
    s_nop 0
    buffer_load_dwordx4 v20, s[84:87], s11 offen offset:0 lds
    s_add_u32 m0, s83, 0x1e400
    s_nop 0
    buffer_load_dwordx4 v21, s[84:87], s11 offen offset:0 lds
    s_add_u32 m0, s83, 0x1fc00
    s_nop 0
    buffer_load_dwordx4 v20, s[84:87], s11 offen offset:1024 lds
    s_add_u32 m0, s83, 0x20000
    s_nop 0
    buffer_load_dwordx4 v21, s[84:87], s11 offen offset:1024 lds
    s_add_u32 m0, s83, 0x21800
    s_nop 0
    buffer_load_dwordx4 v20, s[84:87], s11 offen offset:2048 lds
    s_add_u32 m0, s83, 0x21c00
    s_nop 0
    buffer_load_dwordx4 v21, s[84:87], s11 offen offset:2048 lds
    s_add_u32 s11, s11, 0x30000
    s_cmp_eq_u32 s11, 0x180000
    s_cselect_b32 s11, 0, s11
    s_waitcnt vmcnt(12)
    s_barrier
    s_add_u32 m0, s83, 0x12000
    s_nop 0
    buffer_load_dwordx4 v20, s[84:87], s11 offen offset:0 lds
    s_add_u32 m0, s83, 0x12400
    s_nop 0
    buffer_load_dwordx4 v21, s[84:87], s11 offen offset:0 lds
    s_add_u32 m0, s83, 0x13c00
    s_nop 0
    buffer_load_dwordx4 v20, s[84:87], s11 offen offset:1024 lds
    s_add_u32 m0, s83, 0x14000
    s_nop 0
    buffer_load_dwordx4 v21, s[84:87], s11 offen offset:1024 lds
    s_add_u32 m0, s83, 0x15800
    s_nop 0
    buffer_load_dwordx4 v20, s[84:87], s11 offen offset:2048 lds
    s_add_u32 m0, s83, 0x15c00
    s_nop 0
    buffer_load_dwordx4 v21, s[84:87], s11 offen offset:2048 lds
    s_add_u32 s11, s11, 0x30000
    s_cmp_eq_u32 s11, 0x180000
    s_cselect_b32 s11, 0, s11
    s_waitcnt vmcnt(12)
    s_barrier
    s_add_u32 m0, s83, 0x0
    s_nop 0
    buffer_load_dwordx4 v20, s[84:87], s11 offen offset:0 lds
    s_add_u32 m0, s83, 0x400
    s_nop 0
    buffer_load_dwordx4 v21, s[84:87], s11 offen offset:0 lds
    s_add_u32 m0, s83, 0x1c00
    s_nop 0
    buffer_load_dwordx4 v20, s[84:87], s11 offen offset:1024 lds
    s_add_u32 m0, s83, 0x2000
    s_nop 0
    buffer_load_dwordx4 v21, s[84:87], s11 offen offset:1024 lds
    s_add_u32 m0, s83, 0x3800
    s_nop 0
    buffer_load_dwordx4 v20, s[84:87], s11 offen offset:2048 lds
    s_add_u32 m0, s83, 0x3c00
    s_nop 0
    buffer_load_dwordx4 v21, s[84:87], s11 offen offset:2048 lds
    s_add_u32 s11, s11, 0x30000
    s_cmp_eq_u32 s11, 0x180000
    s_cselect_b32 s11, 0, s11
    s_waitcnt vmcnt(12)
    s_barrier
    s_add_u32 m0, s83, 0x6000
    s_nop 0
    buffer_load_dwordx4 v20, s[84:87], s11 offen offset:0 lds
    s_add_u32 m0, s83, 0x6400
    s_nop 0
    buffer_load_dwordx4 v21, s[84:87], s11 offen offset:0 lds
    s_add_u32 m0, s83, 0x7c00
    s_nop 0
    buffer_load_dwordx4 v20, s[84:87], s11 offen offset:1024 lds
    s_add_u32 m0, s83, 0x8000
    s_nop 0
    buffer_load_dwordx4 v21, s[84:87], s11 offen offset:1024 lds
    s_add_u32 m0, s83, 0x9800
    s_nop 0
    buffer_load_dwordx4 v20, s[84:87], s11 offen offset:2048 lds
    s_add_u32 m0, s83, 0x9c00
    s_nop 0
    buffer_load_dwordx4 v21, s[84:87], s11 offen offset:2048 lds
    s_add_u32 s11, s11, 0x30000
    s_cmp_eq_u32 s11, 0x180000
    s_cselect_b32 s11, 0, s11
    s_waitcnt lgkmcnt(0)
    buffer_load_dwordx2 v[18:19], v17, s[28:31], s48 offen sc1
    s_waitcnt vmcnt(13)
    s_barrier
    s_waitcnt vmcnt(1)
    s_barrier
    s_setprio 3
    s_waitcnt vmcnt(0)
    v_cmp_ne_u64 vcc, s[76:77], v[18:19]
    s_cbranch_vccz LPOLLD
    s_mov_b32 s78, 0
POLL2:
    buffer_load_dwordx2 v[18:19], v17, s[28:31], s48 offen sc1
    s_add_u32 s78, s78, 1
    s_cmp_lt_u32 s78, 65536
    s_cselect_b64 s[96:97], -1, 0
    s_waitcnt vmcnt(0)
    v_cmp_ne_u64 vcc, s[76:77], v[18:19]
    s_nop 0
    s_and_b64 s[96:97], vcc, s[96:97]
    s_cbranch_scc1 POLL2
LPOLLD:
    s_mov_b32 s54, s52
    buffer_load_dwordx4 v[128:131], v6, s[28:31], s54 offen offset:0 sc1
    buffer_load_dwordx4 v[140:143], v6, s[28:31], s54 offen offset:2048 sc1
    s_mov_b64 exec, s[60:61]
    buffer_load_dwordx4 v[132:135], v3, s[28:31], s54 offen offset:1024 sc1
    buffer_load_dwordx4 v[136:139], v3, s[28:31], s54 offen offset:1536 sc1
    buffer_load_dwordx4 v[144:147], v3, s[28:31], s54 offen offset:3072 sc1
    buffer_load_dwordx4 v[148:151], v3, s[28:31], s54 offen offset:3584 sc1
    s_mov_b64 exec, -1
    s_add_u32 s54, s54, 4096
    s_mov_b32 s20, s14
    s_mov_b32 s21, s15
    s_mov_b32 s22, 0x80000
    s_mov_b32 s23, 0x20000
    s_waitcnt vmcnt(5)
    v_mfma_f32_32x32x16_bf16 v[48:63], v[128:131], v[8:11], 0
    v_mfma_f32_32x32x16_bf16 v[64:79], v[128:131], v[12:15], 0
    buffer_load_dwordx4 v[152:155], v6, s[28:31], s54 offen offset:0 sc1
    buffer_load_dwordx4 v[164:167], v6, s[28:31], s54 offen offset:2048 sc1
    s_mov_b64 exec, s[60:61]
    buffer_load_dwordx4 v[156:159], v3, s[28:31], s54 offen offset:1024 sc1
    buffer_load_dwordx4 v[160:163], v3, s[28:31], s54 offen offset:1536 sc1
    buffer_load_dwordx4 v[168:171], v3, s[28:31], s54 offen offset:3072 sc1
    buffer_load_dwordx4 v[172:175], v3, s[28:31], s54 offen offset:3584 sc1
    s_mov_b64 exec, -1
    s_add_u32 s54, s54, 4096
    buffer_load_dwordx4 v[176:179], v6, s[28:31], s54 offen offset:0 sc1
    buffer_load_dwordx4 v[188:191], v6, s[28:31], s54 offen offset:2048 sc1
    s_mov_b64 exec, s[60:61]
    buffer_load_dwordx4 v[180:183], v3, s[28:31], s54 offen offset:1024 sc1
    buffer_load_dwordx4 v[184:187], v3, s[28:31], s54 offen offset:1536 sc1
    buffer_load_dwordx4 v[192:195], v3, s[28:31], s54 offen offset:3072 sc1
    buffer_load_dwordx4 v[196:199], v3, s[28:31], s54 offen offset:3584 sc1
    s_mov_b64 exec, -1
    s_add_u32 s54, s54, 4096
    v_max3_f32 v92, v48, v49, v50
    v_max3_f32 v92, v92, v51, v52
    v_max3_f32 v92, v92, v53, v54
    v_max3_f32 v92, v92, v55, v56
    v_max3_f32 v92, v92, v57, v58
    v_max3_f32 v92, v92, v59, v60
    v_max3_f32 v92, v92, v61, v62
    v_max_f32 v92, v92, v63
    v_add_f32 v92, 0x42200000, v92
    v_cvt_pk_bf16_f32 v84, -v92, 0
    s_nop 1
    v_mfma_f32_32x32x16_bf16 v[16:31], v[80:83], v[84:87], 0
    v_max3_f32 v93, v64, v65, v66
    v_max3_f32 v93, v93, v67, v68
    v_max3_f32 v93, v93, v69, v70
    v_max3_f32 v93, v93, v71, v72
    v_max3_f32 v93, v93, v73, v74
    v_max3_f32 v93, v93, v75, v76
    v_max3_f32 v93, v93, v77, v78
    v_max_f32 v93, v93, v79
    v_add_f32 v93, 0x42200000, v93
    v_cvt_pk_bf16_f32 v88, -v93, 0
    s_nop 1
    v_mfma_f32_32x32x16_bf16 v[32:47], v[80:83], v[88:91], 0
A_MAIN_L:
    v_mov_b32 v48, 0
    v_mov_b32 v49, 0
    v_mov_b32 v50, 0
    v_mov_b32 v51, 0
    v_mov_b32 v52, 0
    v_mov_b32 v53, 0
    v_mov_b32 v54, 0
    v_mov_b32 v55, 0
    v_mov_b32 v56, 0
    v_mov_b32 v57, 0
    v_mov_b32 v58, 0
    v_mov_b32 v59, 0
    v_mov_b32 v60, 0
    v_mov_b32 v61, 0
    v_mov_b32 v62, 0
    v_mov_b32 v63, 0
    v_mov_b32 v64, 0
    v_mov_b32 v65, 0
    v_mov_b32 v66, 0
    v_mov_b32 v67, 0
    v_mov_b32 v68, 0
    v_mov_b32 v69, 0
    v_mov_b32 v70, 0
    v_mov_b32 v71, 0
    v_mov_b32 v72, 0
    v_mov_b32 v73, 0
    v_mov_b32 v74, 0
    v_mov_b32 v75, 0
    v_mov_b32 v76, 0
    v_mov_b32 v77, 0
    v_mov_b32 v78, 0
    v_mov_b32 v79, 0
    v_mfma_f32_32x32x16_bf16 v[80:95], v[128:131], v[8:11], v[16:31]
    v_mfma_f32_32x32x16_bf16 v[96:111], v[128:131], v[12:15], v[32:47]
    s_nop 10
    v_exp_f32 v80, v80
    v_exp_f32 v81, v81
    v_exp_f32 v82, v82
    v_exp_f32 v83, v83
    v_exp_f32 v84, v84
    v_exp_f32 v85, v85
    buffer_load_dwordx4 v[200:203], v6, s[28:31], s54 offen offset:0 sc1
    buffer_load_dwordx4 v[212:215], v6, s[28:31], s54 offen offset:2048 sc1
    s_mov_b64 exec, s[60:61]
    buffer_load_dwordx4 v[204:207], v3, s[28:31], s54 offen offset:1024 sc1
    buffer_load_dwordx4 v[208:211], v3, s[28:31], s54 offen offset:1536 sc1
    buffer_load_dwordx4 v[216:219], v3, s[28:31], s54 offen offset:3072 sc1
    buffer_load_dwordx4 v[220:223], v3, s[28:31], s54 offen offset:3584 sc1
    s_mov_b64 exec, -1
    s_add_u32 s54, s54, 4096
    s_setprio 3
    v_exp_f32 v86, v86
    v_exp_f32 v87, v87
    s_waitcnt vmcnt(22)
    v_mfma_f32_32x32x16_bf16 v[112:127], v[140:143], v[8:11], v[16:31]
    v_exp_f32 v88, v88
    v_exp_f32 v89, v89
    v_exp_f32 v90, v90
    v_exp_f32 v91, v91
    v_exp_f32 v92, v92
    s_waitcnt vmcnt(20)
    v_smfmac_f32_32x32x32_bf16 v[48:63], v[132:135], v[80:87], v7
    v_exp_f32 v93, v93
    v_exp_f32 v94, v94
    v_exp_f32 v95, v95
    v_exp_f32 v96, v96
    v_exp_f32 v97, v97
    v_exp_f32 v98, v98
    v_smfmac_f32_32x32x32_bf16 v[48:63], v[136:139], v[88:95], v7
    v_exp_f32 v99, v99
    v_exp_f32 v100, v100
    v_exp_f32 v101, v101
    v_exp_f32 v102, v102
    v_exp_f32 v103, v103
    v_mfma_f32_32x32x16_bf16 v[80:95], v[140:143], v[12:15], v[32:47]
    v_exp_f32 v104, v104
    v_exp_f32 v105, v105
    v_exp_f32 v106, v106
    v_exp_f32 v107, v107
    v_exp_f32 v108, v108
    v_smfmac_f32_32x32x32_bf16 v[64:79], v[132:135], v[96:103], v7
    v_exp_f32 v109, v109
    v_exp_f32 v110, v110
    v_exp_f32 v111, v111
    v_exp_f32 v112, v112
    v_exp_f32 v113, v113
    v_exp_f32 v114, v114
    v_smfmac_f32_32x32x32_bf16 v[64:79], v[136:139], v[104:111], v7
    v_exp_f32 v115, v115
    v_exp_f32 v116, v116
    v_exp_f32 v117, v117
    s_setprio 2
    v_exp_f32 v118, v118
    v_exp_f32 v119, v119
    s_waitcnt vmcnt(17)
    v_mfma_f32_32x32x16_bf16 v[96:111], v[152:155], v[8:11], v[16:31]
    v_exp_f32 v120, v120
    v_exp_f32 v121, v121
    v_exp_f32 v122, v122
    v_exp_f32 v123, v123
    v_exp_f32 v124, v124
    v_smfmac_f32_32x32x32_bf16 v[48:63], v[144:147], v[112:119], v7
    v_exp_f32 v125, v125
    v_exp_f32 v126, v126
    v_exp_f32 v127, v127
    v_exp_f32 v80, v80
    v_exp_f32 v81, v81
    v_exp_f32 v82, v82
    v_smfmac_f32_32x32x32_bf16 v[48:63], v[148:151], v[120:127], v7
    v_exp_f32 v83, v83
    v_exp_f32 v84, v84
    v_exp_f32 v85, v85
    s_setprio 1
    v_exp_f32 v86, v86
    v_exp_f32 v87, v87
    v_mfma_f32_32x32x16_bf16 v[112:127], v[152:155], v[12:15], v[32:47]
    v_exp_f32 v88, v88
    v_exp_f32 v89, v89
    v_exp_f32 v90, v90
    v_exp_f32 v91, v91
    v_exp_f32 v92, v92
    v_smfmac_f32_32x32x32_bf16 v[64:79], v[144:147], v[80:87], v7
    v_exp_f32 v93, v93
    v_exp_f32 v94, v94
    v_exp_f32 v95, v95
    v_exp_f32 v96, v96
    v_exp_f32 v97, v97
    v_exp_f32 v98, v98
    v_smfmac_f32_32x32x32_bf16 v[64:79], v[148:151], v[88:95], v7
    v_exp_f32 v99, v99
    v_exp_f32 v100, v100
    v_exp_f32 v101, v101
    buffer_load_dwordx4 v[128:131], v6, s[28:31], s54 offen offset:0 sc1
    buffer_load_dwordx4 v[140:143], v6, s[28:31], s54 offen offset:2048 sc1
    s_mov_b64 exec, s[60:61]
    buffer_load_dwordx4 v[132:135], v3, s[28:31], s54 offen offset:1024 sc1
    buffer_load_dwordx4 v[136:139], v3, s[28:31], s54 offen offset:1536 sc1
    buffer_load_dwordx4 v[144:147], v3, s[28:31], s54 offen offset:3072 sc1
    buffer_load_dwordx4 v[148:151], v3, s[28:31], s54 offen offset:3584 sc1
    s_mov_b64 exec, -1
    s_add_u32 s54, s54, 4096
    v_exp_f32 v102, v102
    v_exp_f32 v103, v103
    s_waitcnt vmcnt(22)
    v_mfma_f32_32x32x16_bf16 v[80:95], v[164:167], v[8:11], v[16:31]
    v_exp_f32 v104, v104
    v_exp_f32 v105, v105
    v_exp_f32 v106, v106
    v_exp_f32 v107, v107
    v_exp_f32 v108, v108
    s_waitcnt vmcnt(20)
    v_smfmac_f32_32x32x32_bf16 v[48:63], v[156:159], v[96:103], v7
    v_exp_f32 v109, v109
    v_exp_f32 v110, v110
    v_exp_f32 v111, v111
    v_exp_f32 v112, v112
    v_exp_f32 v113, v113
    v_exp_f32 v114, v114
    v_smfmac_f32_32x32x32_bf16 v[48:63], v[160:163], v[104:111], v7
    v_exp_f32 v115, v115
    v_exp_f32 v116, v116
    v_exp_f32 v117, v117
    s_setprio 0
    v_exp_f32 v118, v118
    v_exp_f32 v119, v119
    v_mfma_f32_32x32x16_bf16 v[96:111], v[164:167], v[12:15], v[32:47]
    v_exp_f32 v120, v120
    v_exp_f32 v121, v121
    v_exp_f32 v122, v122
    v_exp_f32 v123, v123
    v_exp_f32 v124, v124
    v_smfmac_f32_32x32x32_bf16 v[64:79], v[156:159], v[112:119], v7
    v_exp_f32 v125, v125
    v_exp_f32 v126, v126
    v_exp_f32 v127, v127
    v_exp_f32 v80, v80
    v_exp_f32 v81, v81
    v_exp_f32 v82, v82
    v_smfmac_f32_32x32x32_bf16 v[64:79], v[160:163], v[120:127], v7
    v_exp_f32 v83, v83
    v_exp_f32 v84, v84
    v_exp_f32 v85, v85
    s_setprio 3
    v_exp_f32 v86, v86
    v_exp_f32 v87, v87
    s_waitcnt vmcnt(17)
    v_mfma_f32_32x32x16_bf16 v[112:127], v[176:179], v[8:11], v[16:31]
    v_exp_f32 v88, v88
    v_exp_f32 v89, v89
    v_exp_f32 v90, v90
    v_exp_f32 v91, v91
    v_exp_f32 v92, v92
    v_smfmac_f32_32x32x32_bf16 v[48:63], v[168:171], v[80:87], v7
    v_exp_f32 v93, v93
    v_exp_f32 v94, v94
    v_exp_f32 v95, v95
    v_exp_f32 v96, v96
    v_exp_f32 v97, v97
    v_exp_f32 v98, v98
    v_smfmac_f32_32x32x32_bf16 v[48:63], v[172:175], v[88:95], v7
    v_exp_f32 v99, v99
    v_exp_f32 v100, v100
    v_exp_f32 v101, v101
    v_exp_f32 v102, v102
    v_exp_f32 v103, v103
    v_mfma_f32_32x32x16_bf16 v[80:95], v[176:179], v[12:15], v[32:47]
    v_exp_f32 v104, v104
    v_exp_f32 v105, v105
    v_exp_f32 v106, v106
    v_exp_f32 v107, v107
    v_exp_f32 v108, v108
    v_smfmac_f32_32x32x32_bf16 v[64:79], v[168:171], v[96:103], v7
    v_exp_f32 v109, v109
    v_exp_f32 v110, v110
    v_exp_f32 v111, v111
    v_exp_f32 v112, v112
    v_exp_f32 v113, v113
    v_exp_f32 v114, v114
    v_smfmac_f32_32x32x32_bf16 v[64:79], v[172:175], v[104:111], v7
    v_exp_f32 v115, v115
    v_exp_f32 v116, v116
    v_exp_f32 v117, v117
    buffer_load_dwordx4 v[152:155], v6, s[28:31], s54 offen offset:0 sc1
    buffer_load_dwordx4 v[164:167], v6, s[28:31], s54 offen offset:2048 sc1
    s_mov_b64 exec, s[60:61]
    buffer_load_dwordx4 v[156:159], v3, s[28:31], s54 offen offset:1024 sc1
    buffer_load_dwordx4 v[160:163], v3, s[28:31], s54 offen offset:1536 sc1
    buffer_load_dwordx4 v[168:171], v3, s[28:31], s54 offen offset:3072 sc1
    buffer_load_dwordx4 v[172:175], v3, s[28:31], s54 offen offset:3584 sc1
    s_mov_b64 exec, -1
    s_add_u32 s54, s54, 4096
    s_setprio 2
    v_exp_f32 v118, v118
    v_exp_f32 v119, v119
    s_waitcnt vmcnt(22)
    v_mfma_f32_32x32x16_bf16 v[96:111], v[188:191], v[8:11], v[16:31]
    v_exp_f32 v120, v120
    v_exp_f32 v121, v121
    v_exp_f32 v122, v122
    v_exp_f32 v123, v123
    v_exp_f32 v124, v124
    s_waitcnt vmcnt(20)
    v_smfmac_f32_32x32x32_bf16 v[48:63], v[180:183], v[112:119], v7
    v_exp_f32 v125, v125
    v_exp_f32 v126, v126
    v_exp_f32 v127, v127
    v_exp_f32 v80, v80
    v_exp_f32 v81, v81
    v_exp_f32 v82, v82
    v_smfmac_f32_32x32x32_bf16 v[48:63], v[184:187], v[120:127], v7
    v_exp_f32 v83, v83
    v_exp_f32 v84, v84
    v_exp_f32 v85, v85
    s_setprio 1
    v_exp_f32 v86, v86
    v_exp_f32 v87, v87
    v_mfma_f32_32x32x16_bf16 v[112:127], v[188:191], v[12:15], v[32:47]
    v_exp_f32 v88, v88
    v_exp_f32 v89, v89
    v_exp_f32 v90, v90
    v_exp_f32 v91, v91
    v_exp_f32 v92, v92
    v_smfmac_f32_32x32x32_bf16 v[64:79], v[180:183], v[80:87], v7
    v_exp_f32 v93, v93
    v_exp_f32 v94, v94
    v_exp_f32 v95, v95
    v_exp_f32 v96, v96
    v_exp_f32 v97, v97
    v_exp_f32 v98, v98
    v_smfmac_f32_32x32x32_bf16 v[64:79], v[184:187], v[88:95], v7
    v_exp_f32 v99, v99
    v_exp_f32 v100, v100
    v_exp_f32 v101, v101
    v_exp_f32 v102, v102
    v_exp_f32 v103, v103
    s_waitcnt vmcnt(17)
    v_mfma_f32_32x32x16_bf16 v[80:95], v[200:203], v[8:11], v[16:31]
    v_exp_f32 v104, v104
    v_exp_f32 v105, v105
    v_exp_f32 v106, v106
    v_exp_f32 v107, v107
    v_exp_f32 v108, v108
    v_smfmac_f32_32x32x32_bf16 v[48:63], v[192:195], v[96:103], v7
    v_exp_f32 v109, v109
    v_exp_f32 v110, v110
    v_exp_f32 v111, v111
    v_exp_f32 v112, v112
    v_exp_f32 v113, v113
    v_exp_f32 v114, v114
    v_smfmac_f32_32x32x32_bf16 v[48:63], v[196:199], v[104:111], v7
    v_exp_f32 v115, v115
    v_exp_f32 v116, v116
    v_exp_f32 v117, v117
    v_mov_b32 v237, s76
    s_mov_b64 exec, 3
    buffer_store_dwordx2 v[236:237], v238, s[28:31], s10 offen sc1
    s_mov_b64 exec, -1
    s_setprio 0
    v_exp_f32 v118, v118
    v_exp_f32 v119, v119
    v_mfma_f32_32x32x16_bf16 v[96:111], v[200:203], v[12:15], v[32:47]
    v_exp_f32 v120, v120
    v_exp_f32 v121, v121
    v_exp_f32 v122, v122
    v_exp_f32 v123, v123
    v_exp_f32 v124, v124
    v_smfmac_f32_32x32x32_bf16 v[64:79], v[192:195], v[112:119], v7
    v_exp_f32 v125, v125
    v_exp_f32 v126, v126
    v_exp_f32 v127, v127
    v_exp_f32 v80, v80
    v_exp_f32 v81, v81
    v_exp_f32 v82, v82
    v_smfmac_f32_32x32x32_bf16 v[64:79], v[196:199], v[120:127], v7
    v_exp_f32 v83, v83
    v_exp_f32 v84, v84
    v_exp_f32 v85, v85
    buffer_load_dwordx4 v[176:179], v6, s[28:31], s54 offen offset:0 sc1
    buffer_load_dwordx4 v[188:191], v6, s[28:31], s54 offen offset:2048 sc1
    s_mov_b64 exec, s[60:61]
    buffer_load_dwordx4 v[180:183], v3, s[28:31], s54 offen offset:1024 sc1
    buffer_load_dwordx4 v[184:187], v3, s[28:31], s54 offen offset:1536 sc1
    buffer_load_dwordx4 v[192:195], v3, s[28:31], s54 offen offset:3072 sc1
    buffer_load_dwordx4 v[196:199], v3, s[28:31], s54 offen offset:3584 sc1
    s_mov_b64 exec, -1
    s_add_u32 s54, s54, 4096
    s_setprio 3
    v_exp_f32 v86, v86
    v_exp_f32 v87, v87
    s_waitcnt vmcnt(23)
    v_mfma_f32_32x32x16_bf16 v[112:127], v[212:215], v[8:11], v[16:31]
    v_exp_f32 v88, v88
    v_exp_f32 v89, v89
    v_exp_f32 v90, v90
    v_exp_f32 v91, v91
    v_exp_f32 v92, v92
    s_waitcnt vmcnt(21)
    v_smfmac_f32_32x32x32_bf16 v[48:63], v[204:207], v[80:87], v7
    v_exp_f32 v93, v93
    v_exp_f32 v94, v94
    v_exp_f32 v95, v95
    v_exp_f32 v96, v96
    v_exp_f32 v97, v97
    v_exp_f32 v98, v98
    v_smfmac_f32_32x32x32_bf16 v[48:63], v[208:211], v[88:95], v7
    v_exp_f32 v99, v99
    v_exp_f32 v100, v100
    v_exp_f32 v101, v101
    ds_read_b32 v243, v246
    v_exp_f32 v102, v102
    v_exp_f32 v103, v103
    v_mfma_f32_32x32x16_bf16 v[80:95], v[212:215], v[12:15], v[32:47]
    v_exp_f32 v104, v104
    v_exp_f32 v105, v105
    v_exp_f32 v106, v106
    v_exp_f32 v107, v107
    v_exp_f32 v108, v108
    v_smfmac_f32_32x32x32_bf16 v[64:79], v[204:207], v[96:103], v7
    v_exp_f32 v109, v109
    v_exp_f32 v110, v110
    v_exp_f32 v111, v111
    v_exp_f32 v112, v112
    v_exp_f32 v113, v113
    v_exp_f32 v114, v114
    v_smfmac_f32_32x32x32_bf16 v[64:79], v[208:211], v[104:111], v7
    v_exp_f32 v115, v115
    v_exp_f32 v116, v116
    v_exp_f32 v117, v117
    s_setprio 2
    v_exp_f32 v118, v118
    v_exp_f32 v119, v119
    s_waitcnt vmcnt(18)
    v_mfma_f32_32x32x16_bf16 v[96:111], v[128:131], v[8:11], v[16:31]
    v_exp_f32 v120, v120
    v_exp_f32 v121, v121
    v_exp_f32 v122, v122
    v_exp_f32 v123, v123
    v_exp_f32 v124, v124
    v_smfmac_f32_32x32x32_bf16 v[48:63], v[216:219], v[112:119], v7
    v_exp_f32 v125, v125
    v_exp_f32 v126, v126
    v_exp_f32 v127, v127
    v_exp_f32 v80, v80
    v_exp_f32 v81, v81
    v_exp_f32 v82, v82
    v_smfmac_f32_32x32x32_bf16 v[48:63], v[220:223], v[120:127], v7
    v_exp_f32 v83, v83
    v_exp_f32 v84, v84
    v_exp_f32 v85, v85
    s_setprio 1
    s_waitcnt lgkmcnt(0)
    v_cmp_gt_u32 vcc, 4, v243
    s_cbranch_vccnz LC3_S
LCD3:
    v_exp_f32 v86, v86
    v_exp_f32 v87, v87
    v_mfma_f32_32x32x16_bf16 v[112:127], v[128:131], v[12:15], v[32:47]
    v_exp_f32 v88, v88
    v_exp_f32 v89, v89
    v_exp_f32 v90, v90
    v_exp_f32 v91, v91
    v_exp_f32 v92, v92
    v_smfmac_f32_32x32x32_bf16 v[64:79], v[216:219], v[80:87], v7
    v_exp_f32 v93, v93
    v_exp_f32 v94, v94
    v_exp_f32 v95, v95
    v_exp_f32 v96, v96
    v_exp_f32 v97, v97
    v_exp_f32 v98, v98
    v_smfmac_f32_32x32x32_bf16 v[64:79], v[220:223], v[88:95], v7
    v_exp_f32 v99, v99
    v_exp_f32 v100, v100
    v_exp_f32 v101, v101
    buffer_load_dwordx4 v[200:203], v6, s[28:31], s54 offen offset:0 sc1
    buffer_load_dwordx4 v[212:215], v6, s[28:31], s54 offen offset:2048 sc1
    s_mov_b64 exec, s[60:61]
    buffer_load_dwordx4 v[204:207], v3, s[28:31], s54 offen offset:1024 sc1
    buffer_load_dwordx4 v[208:211], v3, s[28:31], s54 offen offset:1536 sc1
    buffer_load_dwordx4 v[216:219], v3, s[28:31], s54 offen offset:3072 sc1
    buffer_load_dwordx4 v[220:223], v3, s[28:31], s54 offen offset:3584 sc1
    s_mov_b64 exec, -1
    s_add_u32 s54, s54, 4096
    v_exp_f32 v102, v102
    v_exp_f32 v103, v103
    s_waitcnt vmcnt(23)
    v_mfma_f32_32x32x16_bf16 v[80:95], v[140:143], v[8:11], v[16:31]
    v_exp_f32 v104, v104
    v_exp_f32 v105, v105
    v_exp_f32 v106, v106
    v_exp_f32 v107, v107
    v_exp_f32 v108, v108
    s_waitcnt vmcnt(21)
    v_smfmac_f32_32x32x32_bf16 v[48:63], v[132:135], v[96:103], v7
    v_exp_f32 v109, v109
    v_exp_f32 v110, v110
    v_exp_f32 v111, v111
    v_exp_f32 v112, v112
    v_exp_f32 v113, v113
    v_exp_f32 v114, v114
    v_smfmac_f32_32x32x32_bf16 v[48:63], v[136:139], v[104:111], v7
    v_exp_f32 v115, v115
    v_exp_f32 v116, v116
    v_exp_f32 v117, v117
    s_setprio 0
    s_add_u32 m0, s58, s56
    s_lshl_b32 s57, s56, 3
    s_add_u32 s57, s57, s59
    buffer_load_dwordx4 v226, s[20:23], s57 offen lds
    s_add_u32 s56, s56, 1024
    v_exp_f32 v118, v118
    v_exp_f32 v119, v119
    v_mfma_f32_32x32x16_bf16 v[96:111], v[140:143], v[12:15], v[32:47]
    v_exp_f32 v120, v120
    v_exp_f32 v121, v121
    v_exp_f32 v122, v122
    v_exp_f32 v123, v123
    v_exp_f32 v124, v124
    v_smfmac_f32_32x32x32_bf16 v[64:79], v[132:135], v[112:119], v7
    v_exp_f32 v125, v125
    v_exp_f32 v126, v126
    v_exp_f32 v127, v127
    v_exp_f32 v80, v80
    v_exp_f32 v81, v81
    v_exp_f32 v82, v82
    v_smfmac_f32_32x32x32_bf16 v[64:79], v[136:139], v[120:127], v7
    v_exp_f32 v83, v83
    v_exp_f32 v84, v84
    v_exp_f32 v85, v85
    s_setprio 3
    v_exp_f32 v86, v86
    v_exp_f32 v87, v87
    s_waitcnt vmcnt(19)
    v_mfma_f32_32x32x16_bf16 v[112:127], v[152:155], v[8:11], v[16:31]
    v_exp_f32 v88, v88
    v_exp_f32 v89, v89
    v_exp_f32 v90, v90
    v_exp_f32 v91, v91
    v_exp_f32 v92, v92
    v_smfmac_f32_32x32x32_bf16 v[48:63], v[144:147], v[80:87], v7
    v_exp_f32 v93, v93
    v_exp_f32 v94, v94
    v_exp_f32 v95, v95
    v_exp_f32 v96, v96
    v_exp_f32 v97, v97
    v_exp_f32 v98, v98
    v_smfmac_f32_32x32x32_bf16 v[48:63], v[148:151], v[88:95], v7
    v_exp_f32 v99, v99
    v_exp_f32 v100, v100
    v_exp_f32 v101, v101
    s_add_u32 m0, s58, s56
    s_lshl_b32 s57, s56, 3
    s_add_u32 s57, s57, s59
    buffer_load_dwordx4 v226, s[20:23], s57 offen lds
    s_add_u32 s56, s56, 1024
    v_exp_f32 v102, v102
    v_exp_f32 v103, v103
    v_mfma_f32_32x32x16_bf16 v[80:95], v[152:155], v[12:15], v[32:47]
    v_exp_f32 v104, v104
    v_exp_f32 v105, v105
    v_exp_f32 v106, v106
    v_exp_f32 v107, v107
    v_exp_f32 v108, v108
    v_smfmac_f32_32x32x32_bf16 v[64:79], v[144:147], v[96:103], v7
    v_exp_f32 v109, v109
    v_exp_f32 v110, v110
    v_exp_f32 v111, v111
    v_exp_f32 v112, v112
    v_exp_f32 v113, v113
    v_exp_f32 v114, v114
    v_smfmac_f32_32x32x32_bf16 v[64:79], v[148:151], v[104:111], v7
    v_exp_f32 v115, v115
    v_exp_f32 v116, v116
    v_exp_f32 v117, v117
    buffer_load_dwordx4 v[128:131], v6, s[28:31], s54 offen offset:0 sc1
    buffer_load_dwordx4 v[140:143], v6, s[28:31], s54 offen offset:2048 sc1
    s_mov_b64 exec, s[60:61]
    buffer_load_dwordx4 v[132:135], v3, s[28:31], s54 offen offset:1024 sc1
    buffer_load_dwordx4 v[136:139], v3, s[28:31], s54 offen offset:1536 sc1
    buffer_load_dwordx4 v[144:147], v3, s[28:31], s54 offen offset:3072 sc1
    buffer_load_dwordx4 v[148:151], v3, s[28:31], s54 offen offset:3584 sc1
    s_mov_b64 exec, -1
    s_add_u32 s54, s54, 4096
    s_setprio 2
    v_exp_f32 v118, v118
    v_exp_f32 v119, v119
    s_waitcnt vmcnt(25)
    v_mfma_f32_32x32x16_bf16 v[96:111], v[164:167], v[8:11], v[16:31]
    v_exp_f32 v120, v120
    v_exp_f32 v121, v121
    v_exp_f32 v122, v122
    v_exp_f32 v123, v123
    v_exp_f32 v124, v124
    s_waitcnt vmcnt(23)
    v_smfmac_f32_32x32x32_bf16 v[48:63], v[156:159], v[112:119], v7
    v_exp_f32 v125, v125
    v_exp_f32 v126, v126
    v_exp_f32 v127, v127
    v_exp_f32 v80, v80
    v_exp_f32 v81, v81
    v_exp_f32 v82, v82
    v_smfmac_f32_32x32x32_bf16 v[48:63], v[160:163], v[120:127], v7
    v_exp_f32 v83, v83
    v_exp_f32 v84, v84
    v_exp_f32 v85, v85
    s_setprio 1
    s_add_u32 m0, s58, s56
    s_lshl_b32 s57, s56, 3
    s_add_u32 s57, s57, s59
    buffer_load_dwordx4 v226, s[20:23], s57 offen lds
    s_add_u32 s56, s56, 1024
    v_exp_f32 v86, v86
    v_exp_f32 v87, v87
    v_mfma_f32_32x32x16_bf16 v[112:127], v[164:167], v[12:15], v[32:47]
    v_exp_f32 v88, v88
    v_exp_f32 v89, v89
    v_exp_f32 v90, v90
    v_exp_f32 v91, v91
    v_exp_f32 v92, v92
    v_smfmac_f32_32x32x32_bf16 v[64:79], v[156:159], v[80:87], v7
    v_exp_f32 v93, v93
    v_exp_f32 v94, v94
    v_exp_f32 v95, v95
    v_exp_f32 v96, v96
    v_exp_f32 v97, v97
    v_exp_f32 v98, v98
    v_smfmac_f32_32x32x32_bf16 v[64:79], v[160:163], v[88:95], v7
    v_exp_f32 v99, v99
    v_exp_f32 v100, v100
    v_exp_f32 v101, v101
    v_exp_f32 v102, v102
    v_exp_f32 v103, v103
    s_waitcnt vmcnt(20)
    v_mfma_f32_32x32x16_bf16 v[80:95], v[176:179], v[8:11], v[16:31]
    v_exp_f32 v104, v104
    v_exp_f32 v105, v105
    v_exp_f32 v106, v106
    v_exp_f32 v107, v107
    v_exp_f32 v108, v108
    v_smfmac_f32_32x32x32_bf16 v[48:63], v[168:171], v[96:103], v7
    v_exp_f32 v109, v109
    v_exp_f32 v110, v110
    v_exp_f32 v111, v111
    v_exp_f32 v112, v112
    v_exp_f32 v113, v113
    v_exp_f32 v114, v114
    v_smfmac_f32_32x32x32_bf16 v[48:63], v[172:175], v[104:111], v7
    v_exp_f32 v115, v115
    v_exp_f32 v116, v116
    v_exp_f32 v117, v117
    s_setprio 0
    s_add_u32 m0, s58, s56
    s_lshl_b32 s57, s56, 3
    s_add_u32 s57, s57, s59
    buffer_load_dwordx4 v226, s[20:23], s57 offen lds
    s_add_u32 s56, s56, 1024
    v_exp_f32 v118, v118
    v_exp_f32 v119, v119
    v_mfma_f32_32x32x16_bf16 v[96:111], v[176:179], v[12:15], v[32:47]
    v_exp_f32 v120, v120
    v_exp_f32 v121, v121
    v_exp_f32 v122, v122
    v_exp_f32 v123, v123
    v_exp_f32 v124, v124
    v_smfmac_f32_32x32x32_bf16 v[64:79], v[168:171], v[112:119], v7
    v_exp_f32 v125, v125
    v_exp_f32 v126, v126
    v_exp_f32 v127, v127
    v_exp_f32 v80, v80
    v_exp_f32 v81, v81
    v_exp_f32 v82, v82
    v_smfmac_f32_32x32x32_bf16 v[64:79], v[172:175], v[120:127], v7
    v_exp_f32 v83, v83
    v_exp_f32 v84, v84
    v_exp_f32 v85, v85
    buffer_load_dwordx4 v[152:155], v6, s[28:31], s54 offen offset:0 sc1
    buffer_load_dwordx4 v[164:167], v6, s[28:31], s54 offen offset:2048 sc1
    s_mov_b64 exec, s[60:61]
    buffer_load_dwordx4 v[156:159], v3, s[28:31], s54 offen offset:1024 sc1
    buffer_load_dwordx4 v[160:163], v3, s[28:31], s54 offen offset:1536 sc1
    buffer_load_dwordx4 v[168:171], v3, s[28:31], s54 offen offset:3072 sc1
    buffer_load_dwordx4 v[172:175], v3, s[28:31], s54 offen offset:3584 sc1
    s_mov_b64 exec, -1
    s_add_u32 s54, s54, 4096
    s_setprio 3
    v_exp_f32 v86, v86
    v_exp_f32 v87, v87
    s_waitcnt vmcnt(26)
    v_mfma_f32_32x32x16_bf16 v[112:127], v[188:191], v[8:11], v[16:31]
    v_exp_f32 v88, v88
    v_exp_f32 v89, v89
    v_exp_f32 v90, v90
    v_exp_f32 v91, v91
    v_exp_f32 v92, v92
    s_waitcnt vmcnt(24)
    v_smfmac_f32_32x32x32_bf16 v[48:63], v[180:183], v[80:87], v7
    v_exp_f32 v93, v93
    v_exp_f32 v94, v94
    v_exp_f32 v95, v95
    v_exp_f32 v96, v96
    v_exp_f32 v97, v97
    v_exp_f32 v98, v98
    v_smfmac_f32_32x32x32_bf16 v[48:63], v[184:187], v[88:95], v7
    v_exp_f32 v99, v99
    v_exp_f32 v100, v100
    v_exp_f32 v101, v101
    s_add_u32 m0, s58, s56
    s_lshl_b32 s57, s56, 3
    s_add_u32 s57, s57, s59
    buffer_load_dwordx4 v226, s[20:23], s57 offen lds
    s_add_u32 s56, s56, 1024
    v_exp_f32 v102, v102
    v_exp_f32 v103, v103
    v_mfma_f32_32x32x16_bf16 v[80:95], v[188:191], v[12:15], v[32:47]
    v_exp_f32 v104, v104
    v_exp_f32 v105, v105
    v_exp_f32 v106, v106
    v_exp_f32 v107, v107
    v_exp_f32 v108, v108
    v_smfmac_f32_32x32x32_bf16 v[64:79], v[180:183], v[96:103], v7
    v_exp_f32 v109, v109
    v_exp_f32 v110, v110
    v_exp_f32 v111, v111
    v_exp_f32 v112, v112
    v_exp_f32 v113, v113
    v_exp_f32 v114, v114
    v_smfmac_f32_32x32x32_bf16 v[64:79], v[184:187], v[104:111], v7
    v_exp_f32 v115, v115
    v_exp_f32 v116, v116
    v_exp_f32 v117, v117
    s_setprio 2
    v_exp_f32 v118, v118
    v_exp_f32 v119, v119
    s_waitcnt vmcnt(22)
    v_mfma_f32_32x32x16_bf16 v[96:111], v[200:203], v[8:11], v[16:31]
    v_exp_f32 v120, v120
    v_exp_f32 v121, v121
    v_exp_f32 v122, v122
    v_exp_f32 v123, v123
    v_exp_f32 v124, v124
    v_smfmac_f32_32x32x32_bf16 v[48:63], v[192:195], v[112:119], v7
    v_exp_f32 v125, v125
    v_exp_f32 v126, v126
    v_exp_f32 v127, v127
    v_exp_f32 v80, v80
    v_exp_f32 v81, v81
    v_exp_f32 v82, v82
    v_smfmac_f32_32x32x32_bf16 v[48:63], v[196:199], v[120:127], v7
    v_exp_f32 v83, v83
    v_exp_f32 v84, v84
    v_exp_f32 v85, v85
    s_setprio 1
    s_add_u32 m0, s58, s56
    s_lshl_b32 s57, s56, 3
    s_add_u32 s57, s57, s59
    buffer_load_dwordx4 v226, s[20:23], s57 offen lds
    s_add_u32 s56, s56, 1024
    v_exp_f32 v86, v86
    v_exp_f32 v87, v87
    v_mfma_f32_32x32x16_bf16 v[112:127], v[200:203], v[12:15], v[32:47]
    v_exp_f32 v88, v88
    v_exp_f32 v89, v89
    v_exp_f32 v90, v90
    v_exp_f32 v91, v91
    v_exp_f32 v92, v92
    v_smfmac_f32_32x32x32_bf16 v[64:79], v[192:195], v[80:87], v7
    v_exp_f32 v93, v93
    v_exp_f32 v94, v94
    v_exp_f32 v95, v95
    v_exp_f32 v96, v96
    v_exp_f32 v97, v97
    v_exp_f32 v98, v98
    v_smfmac_f32_32x32x32_bf16 v[64:79], v[196:199], v[88:95], v7
    v_exp_f32 v99, v99
    v_exp_f32 v100, v100
    v_exp_f32 v101, v101
    buffer_load_dwordx4 v[176:179], v6, s[28:31], s54 offen offset:0 sc1
    buffer_load_dwordx4 v[188:191], v6, s[28:31], s54 offen offset:2048 sc1
    s_mov_b64 exec, s[60:61]
    buffer_load_dwordx4 v[180:183], v3, s[28:31], s54 offen offset:1024 sc1
    buffer_load_dwordx4 v[184:187], v3, s[28:31], s54 offen offset:1536 sc1
    buffer_load_dwordx4 v[192:195], v3, s[28:31], s54 offen offset:3072 sc1
    buffer_load_dwordx4 v[196:199], v3, s[28:31], s54 offen offset:3584 sc1
    s_mov_b64 exec, -1
    s_add_u32 s54, s54, 4096
    v_exp_f32 v102, v102
    v_exp_f32 v103, v103
    s_waitcnt vmcnt(28)
    v_mfma_f32_32x32x16_bf16 v[80:95], v[212:215], v[8:11], v[16:31]
    v_exp_f32 v104, v104
    v_exp_f32 v105, v105
    v_exp_f32 v106, v106
    v_exp_f32 v107, v107
    v_exp_f32 v108, v108
    s_waitcnt vmcnt(26)
    v_smfmac_f32_32x32x32_bf16 v[48:63], v[204:207], v[96:103], v7
    v_exp_f32 v109, v109
    v_exp_f32 v110, v110
    v_exp_f32 v111, v111
    v_exp_f32 v112, v112
    v_exp_f32 v113, v113
    v_exp_f32 v114, v114
    v_smfmac_f32_32x32x32_bf16 v[48:63], v[208:211], v[104:111], v7
    v_exp_f32 v115, v115
    v_exp_f32 v116, v116
    v_exp_f32 v117, v117
    s_setprio 0
    s_add_u32 m0, s58, s56
    s_lshl_b32 s57, s56, 3
    s_add_u32 s57, s57, s59
    buffer_load_dwordx4 v226, s[20:23], s57 offen lds
    s_add_u32 s56, s56, 1024
    v_exp_f32 v118, v118
    v_exp_f32 v119, v119
    v_mfma_f32_32x32x16_bf16 v[96:111], v[212:215], v[12:15], v[32:47]
    v_exp_f32 v120, v120
    v_exp_f32 v121, v121
    v_exp_f32 v122, v122
    v_exp_f32 v123, v123
    v_exp_f32 v124, v124
    v_smfmac_f32_32x32x32_bf16 v[64:79], v[204:207], v[112:119], v7
    v_exp_f32 v125, v125
    v_exp_f32 v126, v126
    v_exp_f32 v127, v127
    v_exp_f32 v80, v80
    v_exp_f32 v81, v81
    v_exp_f32 v82, v82
    v_smfmac_f32_32x32x32_bf16 v[64:79], v[208:211], v[120:127], v7
    v_exp_f32 v83, v83
    v_exp_f32 v84, v84
    v_exp_f32 v85, v85
    s_setprio 3
    v_exp_f32 v86, v86
    v_exp_f32 v87, v87
    s_waitcnt vmcnt(22)
    v_mfma_f32_32x32x16_bf16 v[112:127], v[128:131], v[8:11], v[16:31]
    v_exp_f32 v88, v88
    v_exp_f32 v89, v89
    v_exp_f32 v90, v90
    v_exp_f32 v91, v91
    v_exp_f32 v92, v92
    v_smfmac_f32_32x32x32_bf16 v[48:63], v[216:219], v[80:87], v7
    v_exp_f32 v93, v93
    v_exp_f32 v94, v94
    v_exp_f32 v95, v95
    v_exp_f32 v96, v96
    v_exp_f32 v97, v97
    v_exp_f32 v98, v98
    v_smfmac_f32_32x32x32_bf16 v[48:63], v[220:223], v[88:95], v7
    v_exp_f32 v99, v99
    v_exp_f32 v100, v100
    v_exp_f32 v101, v101
    s_add_u32 m0, s58, s56
    s_lshl_b32 s57, s56, 3
    s_add_u32 s57, s57, s59
    buffer_load_dwordx4 v226, s[20:23], s57 offen lds
    s_add_u32 s56, s56, 1024
    v_exp_f32 v102, v102
    v_exp_f32 v103, v103
    v_mfma_f32_32x32x16_bf16 v[80:95], v[128:131], v[12:15], v[32:47]
    v_exp_f32 v104, v104
    v_exp_f32 v105, v105
    v_exp_f32 v106, v106
    v_exp_f32 v107, v107
    v_exp_f32 v108, v108
    v_smfmac_f32_32x32x32_bf16 v[64:79], v[216:219], v[96:103], v7
    v_exp_f32 v109, v109
    v_exp_f32 v110, v110
    v_exp_f32 v111, v111
    v_exp_f32 v112, v112
    v_exp_f32 v113, v113
    v_exp_f32 v114, v114
    v_smfmac_f32_32x32x32_bf16 v[64:79], v[220:223], v[104:111], v7
    v_exp_f32 v115, v115
    v_exp_f32 v116, v116
    v_exp_f32 v117, v117
    buffer_load_dwordx4 v[200:203], v6, s[28:31], s54 offen offset:0 sc1
    buffer_load_dwordx4 v[212:215], v6, s[28:31], s54 offen offset:2048 sc1
    s_mov_b64 exec, s[60:61]
    buffer_load_dwordx4 v[204:207], v3, s[28:31], s54 offen offset:1024 sc1
    buffer_load_dwordx4 v[208:211], v3, s[28:31], s54 offen offset:1536 sc1
    buffer_load_dwordx4 v[216:219], v3, s[28:31], s54 offen offset:3072 sc1
    buffer_load_dwordx4 v[220:223], v3, s[28:31], s54 offen offset:3584 sc1
    s_mov_b64 exec, -1
    s_add_u32 s54, s54, 4096
    s_setprio 2
    v_exp_f32 v118, v118
    v_exp_f32 v119, v119
    s_waitcnt vmcnt(28)
    v_mfma_f32_32x32x16_bf16 v[96:111], v[140:143], v[8:11], v[16:31]
    v_exp_f32 v120, v120
    v_exp_f32 v121, v121
    v_exp_f32 v122, v122
    v_exp_f32 v123, v123
    v_exp_f32 v124, v124
    s_waitcnt vmcnt(26)
    v_smfmac_f32_32x32x32_bf16 v[48:63], v[132:135], v[112:119], v7
    v_exp_f32 v125, v125
    v_exp_f32 v126, v126
    v_exp_f32 v127, v127
    v_exp_f32 v80, v80
    v_exp_f32 v81, v81
    v_exp_f32 v82, v82
    v_smfmac_f32_32x32x32_bf16 v[48:63], v[136:139], v[120:127], v7
    v_exp_f32 v83, v83
    v_exp_f32 v84, v84
    v_exp_f32 v85, v85
    s_setprio 1
    v_exp_f32 v86, v86
    v_exp_f32 v87, v87
    v_mfma_f32_32x32x16_bf16 v[112:127], v[140:143], v[12:15], v[32:47]
    v_exp_f32 v88, v88
    v_exp_f32 v89, v89
    v_exp_f32 v90, v90
    v_exp_f32 v91, v91
    v_exp_f32 v92, v92
    v_smfmac_f32_32x32x32_bf16 v[64:79], v[132:135], v[80:87], v7
    v_exp_f32 v93, v93
    v_exp_f32 v94, v94
    v_exp_f32 v95, v95
    v_exp_f32 v96, v96
    v_exp_f32 v97, v97
    v_exp_f32 v98, v98
    v_smfmac_f32_32x32x32_bf16 v[64:79], v[136:139], v[88:95], v7
    v_exp_f32 v99, v99
    v_exp_f32 v100, v100
    v_exp_f32 v101, v101
    v_exp_f32 v102, v102
    v_exp_f32 v103, v103
    s_waitcnt vmcnt(21)
    v_mfma_f32_32x32x16_bf16 v[80:95], v[152:155], v[8:11], v[16:31]
    v_exp_f32 v104, v104
    v_exp_f32 v105, v105
    v_exp_f32 v106, v106
    v_exp_f32 v107, v107
    v_exp_f32 v108, v108
    v_smfmac_f32_32x32x32_bf16 v[48:63], v[144:147], v[96:103], v7
    v_exp_f32 v109, v109
    v_exp_f32 v110, v110
    v_exp_f32 v111, v111
    v_exp_f32 v112, v112
    v_exp_f32 v113, v113
    v_exp_f32 v114, v114
    v_smfmac_f32_32x32x32_bf16 v[48:63], v[148:151], v[104:111], v7
    v_exp_f32 v115, v115
    v_exp_f32 v116, v116
    v_exp_f32 v117, v117
    s_setprio 0
    s_add_u32 m0, s58, s56
    s_lshl_b32 s57, s56, 3
    s_add_u32 s57, s57, s59
    buffer_load_dwordx4 v226, s[20:23], s57 offen lds
    s_add_u32 s56, s56, 1024
    v_exp_f32 v118, v118
    v_exp_f32 v119, v119
    v_mfma_f32_32x32x16_bf16 v[96:111], v[152:155], v[12:15], v[32:47]
    v_exp_f32 v120, v120
    v_exp_f32 v121, v121
    v_exp_f32 v122, v122
    v_exp_f32 v123, v123
    v_exp_f32 v124, v124
    v_smfmac_f32_32x32x32_bf16 v[64:79], v[144:147], v[112:119], v7
    v_exp_f32 v125, v125
    v_exp_f32 v126, v126
    v_exp_f32 v127, v127
    v_exp_f32 v80, v80
    v_exp_f32 v81, v81
    v_exp_f32 v82, v82
    v_smfmac_f32_32x32x32_bf16 v[64:79], v[148:151], v[120:127], v7
    v_exp_f32 v83, v83
    v_exp_f32 v84, v84
    v_exp_f32 v85, v85
    buffer_load_dwordx4 v[128:131], v6, s[28:31], s54 offen offset:0 sc1
    buffer_load_dwordx4 v[140:143], v6, s[28:31], s54 offen offset:2048 sc1
    s_mov_b64 exec, s[60:61]
    buffer_load_dwordx4 v[132:135], v3, s[28:31], s54 offen offset:1024 sc1
    buffer_load_dwordx4 v[136:139], v3, s[28:31], s54 offen offset:1536 sc1
    buffer_load_dwordx4 v[144:147], v3, s[28:31], s54 offen offset:3072 sc1
    buffer_load_dwordx4 v[148:151], v3, s[28:31], s54 offen offset:3584 sc1
    s_mov_b64 exec, -1
    s_add_u32 s54, s54, 4096
    s_setprio 3
    v_exp_f32 v86, v86
    v_exp_f32 v87, v87
    s_waitcnt vmcnt(27)
    v_mfma_f32_32x32x16_bf16 v[112:127], v[164:167], v[8:11], v[16:31]
    v_exp_f32 v88, v88
    v_exp_f32 v89, v89
    v_exp_f32 v90, v90
    v_exp_f32 v91, v91
    v_exp_f32 v92, v92
    s_waitcnt vmcnt(25)
    v_smfmac_f32_32x32x32_bf16 v[48:63], v[156:159], v[80:87], v7
    v_exp_f32 v93, v93
    v_exp_f32 v94, v94
    v_exp_f32 v95, v95
    v_exp_f32 v96, v96
    v_exp_f32 v97, v97
    v_exp_f32 v98, v98
    v_smfmac_f32_32x32x32_bf16 v[48:63], v[160:163], v[88:95], v7
    v_exp_f32 v99, v99
    v_exp_f32 v100, v100
    v_exp_f32 v101, v101
    s_add_u32 m0, s58, s56
    s_lshl_b32 s57, s56, 3
    s_add_u32 s57, s57, s59
    buffer_load_dwordx4 v226, s[20:23], s57 offen lds
    s_add_u32 s56, s56, 1024
    v_exp_f32 v102, v102
    v_exp_f32 v103, v103
    v_mfma_f32_32x32x16_bf16 v[80:95], v[164:167], v[12:15], v[32:47]
    v_exp_f32 v104, v104
    v_exp_f32 v105, v105
    v_exp_f32 v106, v106
    v_exp_f32 v107, v107
    v_exp_f32 v108, v108
    v_smfmac_f32_32x32x32_bf16 v[64:79], v[156:159], v[96:103], v7
    v_exp_f32 v109, v109
    v_exp_f32 v110, v110
    v_exp_f32 v111, v111
    v_exp_f32 v112, v112
    v_exp_f32 v113, v113
    v_exp_f32 v114, v114
    v_smfmac_f32_32x32x32_bf16 v[64:79], v[160:163], v[104:111], v7
    v_exp_f32 v115, v115
    v_exp_f32 v116, v116
    v_exp_f32 v117, v117
    s_setprio 2
    v_exp_f32 v118, v118
    v_exp_f32 v119, v119
    s_waitcnt vmcnt(21)
    v_mfma_f32_32x32x16_bf16 v[96:111], v[176:179], v[8:11], v[16:31]
    v_exp_f32 v120, v120
    v_exp_f32 v121, v121
    v_exp_f32 v122, v122
    v_exp_f32 v123, v123
    v_exp_f32 v124, v124
    v_smfmac_f32_32x32x32_bf16 v[48:63], v[168:171], v[112:119], v7
    v_exp_f32 v125, v125
    v_exp_f32 v126, v126
    v_exp_f32 v127, v127
    v_exp_f32 v80, v80
    v_exp_f32 v81, v81
    v_exp_f32 v82, v82
    v_smfmac_f32_32x32x32_bf16 v[48:63], v[172:175], v[120:127], v7
    v_exp_f32 v83, v83
    v_exp_f32 v84, v84
    v_exp_f32 v85, v85
    s_setprio 1
    s_add_u32 m0, s58, s56
    s_lshl_b32 s57, s56, 3
    s_add_u32 s57, s57, s59
    buffer_load_dwordx4 v226, s[20:23], s57 offen lds
    s_add_u32 s56, s56, 1024
    v_exp_f32 v86, v86
    v_exp_f32 v87, v87
    v_mfma_f32_32x32x16_bf16 v[112:127], v[176:179], v[12:15], v[32:47]
    v_exp_f32 v88, v88
    v_exp_f32 v89, v89
    v_exp_f32 v90, v90
    v_exp_f32 v91, v91
    v_exp_f32 v92, v92
    v_smfmac_f32_32x32x32_bf16 v[64:79], v[168:171], v[80:87], v7
    v_exp_f32 v93, v93
    v_exp_f32 v94, v94
    v_exp_f32 v95, v95
    v_exp_f32 v96, v96
    v_exp_f32 v97, v97
    v_exp_f32 v98, v98
    v_smfmac_f32_32x32x32_bf16 v[64:79], v[172:175], v[88:95], v7
    v_exp_f32 v99, v99
    v_exp_f32 v100, v100
    v_exp_f32 v101, v101
    buffer_load_dwordx4 v[152:155], v6, s[28:31], s54 offen offset:0 sc1
    buffer_load_dwordx4 v[164:167], v6, s[28:31], s54 offen offset:2048 sc1
    s_mov_b64 exec, s[60:61]
    buffer_load_dwordx4 v[156:159], v3, s[28:31], s54 offen offset:1024 sc1
    buffer_load_dwordx4 v[160:163], v3, s[28:31], s54 offen offset:1536 sc1
    buffer_load_dwordx4 v[168:171], v3, s[28:31], s54 offen offset:3072 sc1
    buffer_load_dwordx4 v[172:175], v3, s[28:31], s54 offen offset:3584 sc1
    s_mov_b64 exec, -1
    s_add_u32 s54, s54, 4096
    v_exp_f32 v102, v102
    v_exp_f32 v103, v103
    s_waitcnt vmcnt(27)
    v_mfma_f32_32x32x16_bf16 v[80:95], v[188:191], v[8:11], v[16:31]
    v_exp_f32 v104, v104
    v_exp_f32 v105, v105
    v_exp_f32 v106, v106
    v_exp_f32 v107, v107
    v_exp_f32 v108, v108
    s_waitcnt vmcnt(25)
    v_smfmac_f32_32x32x32_bf16 v[48:63], v[180:183], v[96:103], v7
    v_exp_f32 v109, v109
    v_exp_f32 v110, v110
    v_exp_f32 v111, v111
    v_exp_f32 v112, v112
    v_exp_f32 v113, v113
    v_exp_f32 v114, v114
    v_smfmac_f32_32x32x32_bf16 v[48:63], v[184:187], v[104:111], v7
    v_exp_f32 v115, v115
    v_exp_f32 v116, v116
    v_exp_f32 v117, v117
    s_setprio 0
    s_add_u32 m0, s58, s56
    s_lshl_b32 s57, s56, 3
    s_add_u32 s57, s57, s59
    buffer_load_dwordx4 v226, s[20:23], s57 offen lds
    s_add_u32 s56, s56, 1024
    v_exp_f32 v118, v118
    v_exp_f32 v119, v119
    v_mfma_f32_32x32x16_bf16 v[96:111], v[188:191], v[12:15], v[32:47]
    v_exp_f32 v120, v120
    v_exp_f32 v121, v121
    v_exp_f32 v122, v122
    v_exp_f32 v123, v123
    v_exp_f32 v124, v124
    v_smfmac_f32_32x32x32_bf16 v[64:79], v[180:183], v[112:119], v7
    v_exp_f32 v125, v125
    v_exp_f32 v126, v126
    v_exp_f32 v127, v127
    v_exp_f32 v80, v80
    v_exp_f32 v81, v81
    v_exp_f32 v82, v82
    v_smfmac_f32_32x32x32_bf16 v[64:79], v[184:187], v[120:127], v7
    v_exp_f32 v83, v83
    v_exp_f32 v84, v84
    v_exp_f32 v85, v85
    v_exp_f32 v86, v86
    v_exp_f32 v87, v87
    s_waitcnt vmcnt(21)
    v_mfma_f32_32x32x16_bf16 v[112:127], v[200:203], v[8:11], v[16:31]
    v_exp_f32 v88, v88
    v_exp_f32 v89, v89
    v_exp_f32 v90, v90
    v_exp_f32 v91, v91
    v_exp_f32 v92, v92
    v_smfmac_f32_32x32x32_bf16 v[48:63], v[192:195], v[80:87], v7
    v_exp_f32 v93, v93
    v_exp_f32 v94, v94
    v_exp_f32 v95, v95
    v_exp_f32 v96, v96
    v_exp_f32 v97, v97
    v_exp_f32 v98, v98
    v_smfmac_f32_32x32x32_bf16 v[48:63], v[196:199], v[88:95], v7
    v_exp_f32 v99, v99
    v_exp_f32 v100, v100
    v_exp_f32 v101, v101
    s_add_u32 m0, s58, s56
    s_lshl_b32 s57, s56, 3
    s_add_u32 s57, s57, s59
    buffer_load_dwordx4 v226, s[20:23], s57 offen lds
    s_add_u32 s56, s56, 1024
    v_exp_f32 v102, v102
    v_exp_f32 v103, v103
    v_mfma_f32_32x32x16_bf16 v[80:95], v[200:203], v[12:15], v[32:47]
    v_exp_f32 v104, v104
    v_exp_f32 v105, v105
    v_exp_f32 v106, v106
    v_exp_f32 v107, v107
    v_exp_f32 v108, v108
    v_smfmac_f32_32x32x32_bf16 v[64:79], v[192:195], v[96:103], v7
    v_exp_f32 v109, v109
    v_exp_f32 v110, v110
    v_exp_f32 v111, v111
    v_exp_f32 v112, v112
    v_exp_f32 v113, v113
    v_exp_f32 v114, v114
    v_smfmac_f32_32x32x32_bf16 v[64:79], v[196:199], v[104:111], v7
    v_exp_f32 v115, v115
    v_exp_f32 v116, v116
    v_exp_f32 v117, v117
    buffer_load_dwordx4 v[176:179], v6, s[28:31], s54 offen offset:0 sc1
    buffer_load_dwordx4 v[188:191], v6, s[28:31], s54 offen offset:2048 sc1
    s_mov_b64 exec, s[60:61]
    buffer_load_dwordx4 v[180:183], v3, s[28:31], s54 offen offset:1024 sc1
    buffer_load_dwordx4 v[184:187], v3, s[28:31], s54 offen offset:1536 sc1
    buffer_load_dwordx4 v[192:195], v3, s[28:31], s54 offen offset:3072 sc1
    buffer_load_dwordx4 v[196:199], v3, s[28:31], s54 offen offset:3584 sc1
    s_mov_b64 exec, -1
    s_add_u32 s54, s54, 4096
    v_exp_f32 v118, v118
    v_exp_f32 v119, v119
    s_waitcnt vmcnt(27)
    v_mfma_f32_32x32x16_bf16 v[96:111], v[212:215], v[8:11], v[16:31]
    v_exp_f32 v120, v120
    v_exp_f32 v121, v121
    v_exp_f32 v122, v122
    v_exp_f32 v123, v123
    v_exp_f32 v124, v124
    s_waitcnt vmcnt(25)
    v_smfmac_f32_32x32x32_bf16 v[48:63], v[204:207], v[112:119], v7
    v_exp_f32 v125, v125
    v_exp_f32 v126, v126
    v_exp_f32 v127, v127
    v_exp_f32 v80, v80
    v_exp_f32 v81, v81
    v_exp_f32 v82, v82
    v_smfmac_f32_32x32x32_bf16 v[48:63], v[208:211], v[120:127], v7
    v_exp_f32 v83, v83
    v_exp_f32 v84, v84
    v_exp_f32 v85, v85
    s_add_u32 m0, s58, s56
    s_lshl_b32 s57, s56, 3
    s_add_u32 s57, s57, s59
    buffer_load_dwordx4 v226, s[20:23], s57 offen lds
    s_add_u32 s56, s56, 1024
    v_exp_f32 v86, v86
    v_exp_f32 v87, v87
    v_mfma_f32_32x32x16_bf16 v[112:127], v[212:215], v[12:15], v[32:47]
    v_exp_f32 v88, v88
    v_exp_f32 v89, v89
    v_exp_f32 v90, v90
    v_exp_f32 v91, v91
    v_exp_f32 v92, v92
    v_smfmac_f32_32x32x32_bf16 v[64:79], v[204:207], v[80:87], v7
    v_exp_f32 v93, v93
    v_exp_f32 v94, v94
    v_exp_f32 v95, v95
    v_exp_f32 v96, v96
    v_exp_f32 v97, v97
    v_exp_f32 v98, v98
    v_smfmac_f32_32x32x32_bf16 v[64:79], v[208:211], v[88:95], v7
    v_exp_f32 v99, v99
    v_exp_f32 v100, v100
    v_exp_f32 v101, v101
    v_exp_f32 v102, v102
    v_exp_f32 v103, v103
    s_waitcnt vmcnt(22)
    v_mfma_f32_32x32x16_bf16 v[80:95], v[128:131], v[8:11], v[16:31]
    v_exp_f32 v104, v104
    v_exp_f32 v105, v105
    v_exp_f32 v106, v106
    v_exp_f32 v107, v107
    v_exp_f32 v108, v108
    v_smfmac_f32_32x32x32_bf16 v[48:63], v[216:219], v[96:103], v7
    v_exp_f32 v109, v109
    v_exp_f32 v110, v110
    v_exp_f32 v111, v111
    v_exp_f32 v112, v112
    v_exp_f32 v113, v113
    v_exp_f32 v114, v114
    v_smfmac_f32_32x32x32_bf16 v[48:63], v[220:223], v[104:111], v7
    v_exp_f32 v115, v115
    v_exp_f32 v116, v116
    v_exp_f32 v117, v117
    s_add_u32 m0, s58, s56
    s_lshl_b32 s57, s56, 3
    s_add_u32 s57, s57, s59
    buffer_load_dwordx4 v226, s[20:23], s57 offen lds
    s_add_u32 s56, s56, 1024
    v_exp_f32 v118, v118
    v_exp_f32 v119, v119
    v_mfma_f32_32x32x16_bf16 v[96:111], v[128:131], v[12:15], v[32:47]
    v_exp_f32 v120, v120
    v_exp_f32 v121, v121
    v_exp_f32 v122, v122
    v_exp_f32 v123, v123
    v_exp_f32 v124, v124
    v_smfmac_f32_32x32x32_bf16 v[64:79], v[216:219], v[112:119], v7
    v_exp_f32 v125, v125
    v_exp_f32 v126, v126
    v_exp_f32 v127, v127
    v_exp_f32 v80, v80
    v_exp_f32 v81, v81
    v_exp_f32 v82, v82
    v_smfmac_f32_32x32x32_bf16 v[64:79], v[220:223], v[120:127], v7
    v_exp_f32 v83, v83
    v_exp_f32 v84, v84
    v_exp_f32 v85, v85
    buffer_load_dwordx4 v[200:203], v6, s[28:31], s54 offen offset:0 sc1
    buffer_load_dwordx4 v[212:215], v6, s[28:31], s54 offen offset:2048 sc1
    s_mov_b64 exec, s[60:61]
    buffer_load_dwordx4 v[204:207], v3, s[28:31], s54 offen offset:1024 sc1
    buffer_load_dwordx4 v[208:211], v3, s[28:31], s54 offen offset:1536 sc1
    buffer_load_dwordx4 v[216:219], v3, s[28:31], s54 offen offset:3072 sc1
    buffer_load_dwordx4 v[220:223], v3, s[28:31], s54 offen offset:3584 sc1
    s_mov_b64 exec, -1
    s_add_u32 s54, s54, 4096
    v_exp_f32 v86, v86
    v_exp_f32 v87, v87
    s_waitcnt vmcnt(28)
    v_mfma_f32_32x32x16_bf16 v[112:127], v[140:143], v[8:11], v[16:31]
    v_exp_f32 v88, v88
    v_exp_f32 v89, v89
    v_exp_f32 v90, v90
    v_exp_f32 v91, v91
    v_exp_f32 v92, v92
    s_waitcnt vmcnt(26)
    v_smfmac_f32_32x32x32_bf16 v[48:63], v[132:135], v[80:87], v7
    v_exp_f32 v93, v93
    v_exp_f32 v94, v94
    v_exp_f32 v95, v95
    v_exp_f32 v96, v96
    v_exp_f32 v97, v97
    v_exp_f32 v98, v98
    v_smfmac_f32_32x32x32_bf16 v[48:63], v[136:139], v[88:95], v7
    v_exp_f32 v99, v99
    v_exp_f32 v100, v100
    v_exp_f32 v101, v101
    s_add_u32 m0, s58, s56
    s_lshl_b32 s57, s56, 3
    s_add_u32 s57, s57, s59
    buffer_load_dwordx4 v226, s[20:23], s57 offen lds
    s_add_u32 s56, s56, 1024
    v_exp_f32 v102, v102
    v_exp_f32 v103, v103
    v_mfma_f32_32x32x16_bf16 v[80:95], v[140:143], v[12:15], v[32:47]
    v_exp_f32 v104, v104
    v_exp_f32 v105, v105
    v_exp_f32 v106, v106
    v_exp_f32 v107, v107
    v_exp_f32 v108, v108
    v_smfmac_f32_32x32x32_bf16 v[64:79], v[132:135], v[96:103], v7
    v_exp_f32 v109, v109
    v_exp_f32 v110, v110
    v_exp_f32 v111, v111
    v_exp_f32 v112, v112
    v_exp_f32 v113, v113
    v_exp_f32 v114, v114
    v_smfmac_f32_32x32x32_bf16 v[64:79], v[136:139], v[104:111], v7
    v_exp_f32 v115, v115
    v_exp_f32 v116, v116
    v_exp_f32 v117, v117
    v_exp_f32 v118, v118
    v_exp_f32 v119, v119
    s_waitcnt vmcnt(22)
    v_mfma_f32_32x32x16_bf16 v[96:111], v[152:155], v[8:11], v[16:31]
    v_exp_f32 v120, v120
    v_exp_f32 v121, v121
    v_exp_f32 v122, v122
    v_exp_f32 v123, v123
    v_exp_f32 v124, v124
    v_smfmac_f32_32x32x32_bf16 v[48:63], v[144:147], v[112:119], v7
    v_exp_f32 v125, v125
    v_exp_f32 v126, v126
    v_exp_f32 v127, v127
    v_exp_f32 v80, v80
    v_exp_f32 v81, v81
    v_exp_f32 v82, v82
    v_smfmac_f32_32x32x32_bf16 v[48:63], v[148:151], v[120:127], v7
    v_exp_f32 v83, v83
    v_exp_f32 v84, v84
    v_exp_f32 v85, v85
    v_exp_f32 v86, v86
    v_exp_f32 v87, v87
    v_mfma_f32_32x32x16_bf16 v[112:127], v[152:155], v[12:15], v[32:47]
    v_exp_f32 v88, v88
    v_exp_f32 v89, v89
    v_exp_f32 v90, v90
    v_exp_f32 v91, v91
    v_exp_f32 v92, v92
    v_smfmac_f32_32x32x32_bf16 v[64:79], v[144:147], v[80:87], v7
    v_exp_f32 v93, v93
    v_exp_f32 v94, v94
    v_exp_f32 v95, v95
    v_exp_f32 v96, v96
    v_exp_f32 v97, v97
    v_exp_f32 v98, v98
    v_smfmac_f32_32x32x32_bf16 v[64:79], v[148:151], v[88:95], v7
    v_exp_f32 v99, v99
    v_exp_f32 v100, v100
    v_exp_f32 v101, v101
    v_exp_f32 v102, v102
    v_exp_f32 v103, v103
    s_waitcnt vmcnt(21)
    v_mfma_f32_32x32x16_bf16 v[80:95], v[164:167], v[8:11], v[16:31]
    v_exp_f32 v104, v104
    v_exp_f32 v105, v105
    v_exp_f32 v106, v106
    v_exp_f32 v107, v107
    v_exp_f32 v108, v108
    s_waitcnt vmcnt(19)
    v_smfmac_f32_32x32x32_bf16 v[48:63], v[156:159], v[96:103], v7
    v_exp_f32 v109, v109
    v_exp_f32 v110, v110
    v_exp_f32 v111, v111
    v_exp_f32 v112, v112
    v_exp_f32 v113, v113
    v_exp_f32 v114, v114
    v_smfmac_f32_32x32x32_bf16 v[48:63], v[160:163], v[104:111], v7
    v_exp_f32 v115, v115
    v_exp_f32 v116, v116
    v_exp_f32 v117, v117
    v_exp_f32 v118, v118
    v_exp_f32 v119, v119
    v_mfma_f32_32x32x16_bf16 v[96:111], v[164:167], v[12:15], v[32:47]
    v_exp_f32 v120, v120
    v_exp_f32 v121, v121
    v_exp_f32 v122, v122
    v_exp_f32 v123, v123
    v_exp_f32 v124, v124
    v_smfmac_f32_32x32x32_bf16 v[64:79], v[156:159], v[112:119], v7
    v_exp_f32 v125, v125
    v_exp_f32 v126, v126
    v_exp_f32 v127, v127
    v_exp_f32 v80, v80
    v_exp_f32 v81, v81
    v_exp_f32 v82, v82
    v_smfmac_f32_32x32x32_bf16 v[64:79], v[160:163], v[120:127], v7
    v_exp_f32 v83, v83
    v_exp_f32 v84, v84
    v_exp_f32 v85, v85
    ds_read_b32 v243, v246
    v_exp_f32 v86, v86
    v_exp_f32 v87, v87
    s_waitcnt vmcnt(14)
    v_mfma_f32_32x32x16_bf16 v[112:127], v[176:179], v[8:11], v[16:31]
    v_exp_f32 v88, v88
    v_exp_f32 v89, v89
    v_exp_f32 v90, v90
    v_exp_f32 v91, v91
    v_exp_f32 v92, v92
    v_smfmac_f32_32x32x32_bf16 v[48:63], v[168:171], v[80:87], v7
    v_exp_f32 v93, v93
    v_exp_f32 v94, v94
    v_exp_f32 v95, v95
    v_exp_f32 v96, v96
    v_exp_f32 v97, v97
    v_exp_f32 v98, v98
    v_smfmac_f32_32x32x32_bf16 v[48:63], v[172:175], v[88:95], v7
    v_exp_f32 v99, v99
    v_exp_f32 v100, v100
    v_exp_f32 v101, v101
    v_exp_f32 v102, v102
    v_exp_f32 v103, v103
    v_mfma_f32_32x32x16_bf16 v[80:95], v[176:179], v[12:15], v[32:47]
    v_exp_f32 v104, v104
    v_exp_f32 v105, v105
    v_exp_f32 v106, v106
    v_exp_f32 v107, v107
    v_exp_f32 v108, v108
    v_smfmac_f32_32x32x32_bf16 v[64:79], v[168:171], v[96:103], v7
    v_exp_f32 v109, v109
    v_exp_f32 v110, v110
    v_exp_f32 v111, v111
    v_exp_f32 v112, v112
    v_exp_f32 v113, v113
    v_exp_f32 v114, v114
    v_smfmac_f32_32x32x32_bf16 v[64:79], v[172:175], v[104:111], v7
    v_exp_f32 v115, v115
    v_exp_f32 v116, v116
    v_exp_f32 v117, v117
    buffer_load_dwordx2 v[228:229], v225, s[28:31], s74 offen sc1
    buffer_load_dwordx2 v[230:231], v225, s[28:31], s74 offen offset:256 sc1
    buffer_load_dwordx2 v[244:245], v224, s[28:31], s69 offen sc1
    v_exp_f32 v118, v118
    v_exp_f32 v119, v119
    s_waitcnt vmcnt(16)
    v_mfma_f32_32x32x16_bf16 v[96:111], v[188:191], v[8:11], v[16:31]
    v_exp_f32 v120, v120
    v_exp_f32 v121, v121
    v_exp_f32 v122, v122
    v_exp_f32 v123, v123
    v_exp_f32 v124, v124
    s_waitcnt vmcnt(14)
    v_smfmac_f32_32x32x32_bf16 v[48:63], v[180:183], v[112:119], v7
    v_exp_f32 v125, v125
    v_exp_f32 v126, v126
    v_exp_f32 v127, v127
    v_exp_f32 v80, v80
    v_exp_f32 v81, v81
    v_exp_f32 v82, v82
    v_smfmac_f32_32x32x32_bf16 v[48:63], v[184:187], v[120:127], v7
    v_exp_f32 v83, v83
    v_exp_f32 v84, v84
    v_exp_f32 v85, v85
    s_waitcnt lgkmcnt(0)
    v_cmp_gt_u32 vcc, 8, v243
    s_cbranch_vccnz LC4_S
LCD4:
    v_exp_f32 v86, v86
    v_exp_f32 v87, v87
    v_mfma_f32_32x32x16_bf16 v[112:127], v[188:191], v[12:15], v[32:47]
    v_exp_f32 v88, v88
    v_exp_f32 v89, v89
    v_exp_f32 v90, v90
    v_exp_f32 v91, v91
    v_exp_f32 v92, v92
    v_smfmac_f32_32x32x32_bf16 v[64:79], v[180:183], v[80:87], v7
    v_exp_f32 v93, v93
    v_exp_f32 v94, v94
    v_exp_f32 v95, v95
    v_exp_f32 v96, v96
    v_exp_f32 v97, v97
    v_exp_f32 v98, v98
    v_smfmac_f32_32x32x32_bf16 v[64:79], v[184:187], v[88:95], v7
    v_exp_f32 v99, v99
    v_exp_f32 v100, v100
    v_exp_f32 v101, v101
    v_exp_f32 v102, v102
    v_exp_f32 v103, v103
    s_waitcnt vmcnt(9)
    v_mfma_f32_32x32x16_bf16 v[80:95], v[200:203], v[8:11], v[16:31]
    v_exp_f32 v104, v104
    v_exp_f32 v105, v105
    v_exp_f32 v106, v106
    v_exp_f32 v107, v107
    v_exp_f32 v108, v108
    v_smfmac_f32_32x32x32_bf16 v[48:63], v[192:195], v[96:103], v7
    v_exp_f32 v109, v109
    v_exp_f32 v110, v110
    v_exp_f32 v111, v111
    v_exp_f32 v112, v112
    v_exp_f32 v113, v113
    v_exp_f32 v114, v114
    v_smfmac_f32_32x32x32_bf16 v[48:63], v[196:199], v[104:111], v7
    v_exp_f32 v115, v115
    v_exp_f32 v116, v116
    v_exp_f32 v117, v117
    v_exp_f32 v118, v118
    v_exp_f32 v119, v119
    v_mfma_f32_32x32x16_bf16 v[96:111], v[200:203], v[12:15], v[32:47]
    v_exp_f32 v120, v120
    v_exp_f32 v121, v121
    v_exp_f32 v122, v122
    v_exp_f32 v123, v123
    v_exp_f32 v124, v124
    v_smfmac_f32_32x32x32_bf16 v[64:79], v[192:195], v[112:119], v7
    v_exp_f32 v125, v125
    v_exp_f32 v126, v126
    v_exp_f32 v127, v127
    v_exp_f32 v80, v80
    v_exp_f32 v81, v81
    v_exp_f32 v82, v82
    v_smfmac_f32_32x32x32_bf16 v[64:79], v[196:199], v[120:127], v7
    v_exp_f32 v83, v83
    v_exp_f32 v84, v84
    v_exp_f32 v85, v85
    s_waitcnt vmcnt(0)
    v_cmp_ne_u64 vcc, s[76:77], v[244:245]
    s_mov_b32 s55, 0
    s_cbranch_vccnz LOB_SKIP
    buffer_load_dwordx4 v[152:155], v2, s[28:31], s68 offen offset:0 sc1
    buffer_load_dwordx4 v[156:159], v2, s[28:31], s68 offen offset:1024 sc1
    buffer_load_dwordx4 v[160:163], v2, s[28:31], s68 offen offset:2048 sc1
    buffer_load_dwordx4 v[164:167], v2, s[28:31], s68 offen offset:3072 sc1
    buffer_load_dwordx4 v[168:171], v2, s[28:31], s71 offen offset:0 sc1
    buffer_load_dwordx4 v[172:175], v2, s[28:31], s71 offen offset:1024 sc1
    buffer_load_dwordx4 v[176:179], v2, s[28:31], s71 offen offset:2048 sc1
    buffer_load_dwordx4 v[180:183], v2, s[28:31], s71 offen offset:3072 sc1
    s_mov_b32 s55, 1
LOB_SKIP:
    v_exp_f32 v86, v86
    v_exp_f32 v87, v87
    v_mfma_f32_32x32x16_bf16 v[112:127], v[212:215], v[8:11], v[16:31]
    v_exp_f32 v88, v88
    v_exp_f32 v89, v89
    v_exp_f32 v90, v90
    v_exp_f32 v91, v91
    v_exp_f32 v92, v92
    v_smfmac_f32_32x32x32_bf16 v[48:63], v[204:207], v[80:87], v7
    v_exp_f32 v93, v93
    v_exp_f32 v94, v94
    v_exp_f32 v95, v95
    v_exp_f32 v96, v96
    v_exp_f32 v97, v97
    v_exp_f32 v98, v98
    v_smfmac_f32_32x32x32_bf16 v[48:63], v[208:211], v[88:95], v7
    v_exp_f32 v99, v99
    v_exp_f32 v100, v100
    v_exp_f32 v101, v101
    ds_read_b32 v243, v242
    v_exp_f32 v102, v102
    v_exp_f32 v103, v103
    v_mfma_f32_32x32x16_bf16 v[80:95], v[212:215], v[12:15], v[32:47]
    v_exp_f32 v104, v104
    v_exp_f32 v105, v105
    v_exp_f32 v106, v106
    v_exp_f32 v107, v107
    v_exp_f32 v108, v108
    v_smfmac_f32_32x32x32_bf16 v[64:79], v[204:207], v[96:103], v7
    v_exp_f32 v109, v109
    v_exp_f32 v110, v110
    v_exp_f32 v111, v111
    v_exp_f32 v112, v112
    v_exp_f32 v113, v113
    v_exp_f32 v114, v114
    v_smfmac_f32_32x32x32_bf16 v[64:79], v[208:211], v[104:111], v7
    v_exp_f32 v115, v115
    v_exp_f32 v116, v116
    v_exp_f32 v117, v117
    s_setprio 3
    v_exp_f32 v118, v118
    v_exp_f32 v119, v119
    v_exp_f32 v120, v120
    v_exp_f32 v121, v121
    v_exp_f32 v122, v122
    v_exp_f32 v123, v123
    v_exp_f32 v124, v124
    v_smfmac_f32_32x32x32_bf16 v[48:63], v[216:219], v[112:119], v7
    v_exp_f32 v125, v125
    v_exp_f32 v126, v126
    v_exp_f32 v127, v127
    v_exp_f32 v80, v80
    v_exp_f32 v81, v81
    v_exp_f32 v82, v82
    v_smfmac_f32_32x32x32_bf16 v[48:63], v[220:223], v[120:127], v7
    v_exp_f32 v83, v83
    v_exp_f32 v84, v84
    v_exp_f32 v85, v85
    s_waitcnt lgkmcnt(0)
    v_cmp_gt_u32 vcc, 1, v243
    s_cbranch_vccnz LC5_S
LCD5:
    ds_read_b64 v[136:137], v241 offset:2048
    ds_read_b64 v[148:149], v241 offset:4608
    ds_read_b128 v[128:131], v240 offset:0
    ds_read_b128 v[132:135], v240 offset:1024
    ds_read_b128 v[140:143], v240 offset:2560
    ds_read_b128 v[144:147], v240 offset:3584
    v_exp_f32 v86, v86
    v_exp_f32 v87, v87
    v_exp_f32 v88, v88
    v_exp_f32 v89, v89
    v_exp_f32 v90, v90
    v_exp_f32 v91, v91
    v_exp_f32 v92, v92
    v_smfmac_f32_32x32x32_bf16 v[64:79], v[216:219], v[80:87], v7
    v_exp_f32 v93, v93
    v_exp_f32 v94, v94
    v_exp_f32 v95, v95
    v_mov_b32 v112, 0x71800000
    v_mov_b32 v113, 0
    v_smfmac_f32_32x32x32_bf16 v[64:79], v[220:223], v[88:95], v7
    v_mov_b32 v114, 0x1c800000
    v_fma_f32 v113, v48, 0, v113
    v_fma_f32 v113, v49, 0, v113
    v_fma_f32 v113, v50, 0, v113
    v_fma_f32 v113, v51, 0, v113
    v_fma_f32 v113, v52, 0, v113
    v_fma_f32 v113, v53, 0, v113
    v_fma_f32 v113, v54, 0, v113
    v_fma_f32 v113, v55, 0, v113
    v_cmp_lt_f32 s[96:97], v56, v112
    v_cmp_gt_f32 vcc, v56, v114
    v_mov_b32 v57, v16
    s_and_b64 s[96:97], s[96:97], vcc
    v_fma_f32 v113, v64, 0, v113
    v_fma_f32 v113, v65, 0, v113
    v_fma_f32 v113, v66, 0, v113
    v_fma_f32 v113, v67, 0, v113
    v_fma_f32 v113, v68, 0, v113
    v_fma_f32 v113, v69, 0, v113
    v_fma_f32 v113, v70, 0, v113
    v_fma_f32 v113, v71, 0, v113
    v_cmp_lt_f32 s[50:51], v72, v112
    v_cmp_gt_f32 vcc, v72, v114
    v_mov_b32 v73, v32
    s_and_b64 s[50:51], s[50:51], vcc
    v_cmp_o_f32 vcc, v113, v113
    s_and_b64 s[96:97], s[96:97], s[50:51]
    s_and_b64 s[96:97], s[96:97], vcc
    s_or_b64 s[96:97], s[96:97], s[94:95]
    s_cmp_eq_u64 s[96:97], -1
    s_cbranch_scc0 A_FBS_L
    v_cmp_ne_u32 vcc, s76, v229
    v_cmp_ne_u32 s[96:97], s76, v231
    s_waitcnt lgkmcnt(4)
    s_or_b64 s[96:97], s[96:97], vcc
    s_cbranch_scc1 LGATE_S
LGATE_D:
    v_log_f32 v17, v136
    v_log_f32 v16, v56
    v_log_f32 v21, v148
    v_log_f32 v20, v72
    v_sub_f32 v17, v17, v137
    v_sub_f32 v16, v16, v57
    v_sub_f32 v21, v21, v149
    v_sub_f32 v20, v20, v73
    v_max_f32 v16, v16, v17
    v_sub_f32 v17, -v137, v16
    v_sub_f32 v16, -v57, v16
    v_max_f32 v20, v20, v21
    v_sub_f32 v21, -v149, v20
    v_sub_f32 v20, -v73, v20
    v_exp_f32 v17, v17
    v_exp_f32 v16, v16
    v_exp_f32 v21, v21
    v_exp_f32 v20, v20
    v_and_b32 v19, 0xffff0000, v228
    v_mul_f32 v18, v17, v136
    v_fmac_f32 v18, v16, v56
    v_and_b32 v23, 0xffff0000, v230
    v_mul_f32 v22, v21, v148
    v_fmac_f32 v22, v20, v72
    v_rcp_f32 v18, v18
    v_rcp_f32 v22, v22
    s_nop 0
    v_mul_f32 v18, v18, v19
    v_mul_f32 v17, v17, v18
    v_mul_f32 v16, v16, v18
    v_mul_f32 v48, v16, v48
    v_mul_f32 v49, v16, v49
    v_mul_f32 v50, v16, v50
    v_mul_f32 v51, v16, v51
    v_mul_f32 v52, v16, v52
    v_mul_f32 v53, v16, v53
    v_mul_f32 v54, v16, v54
    v_mul_f32 v55, v16, v55
    s_waitcnt lgkmcnt(2)
    v_fmac_f32 v48, v17, v128
    v_fmac_f32 v49, v17, v129
    v_fmac_f32 v50, v17, v130
    v_fmac_f32 v51, v17, v131
    v_fmac_f32 v52, v17, v132
    v_fmac_f32 v53, v17, v133
    v_fmac_f32 v54, v17, v134
    v_fmac_f32 v55, v17, v135
    v_cvt_pk_bf16_f32 v24, v48, v49
    v_cvt_pk_bf16_f32 v25, v50, v51
    v_cvt_pk_bf16_f32 v26, v52, v53
    v_cvt_pk_bf16_f32 v27, v54, v55
    buffer_store_dwordx4 v[24:27], v2, s[28:31], s73 offen sc1
    v_mul_f32 v22, v22, v23
    v_mul_f32 v21, v21, v22
    v_mul_f32 v20, v20, v22
    v_mul_f32 v64, v20, v64
    v_mul_f32 v65, v20, v65
    v_mul_f32 v66, v20, v66
    v_mul_f32 v67, v20, v67
    v_mul_f32 v68, v20, v68
    v_mul_f32 v69, v20, v69
    v_mul_f32 v70, v20, v70
    v_mul_f32 v71, v20, v71
    s_waitcnt lgkmcnt(0)
    v_fmac_f32 v64, v21, v140
    v_fmac_f32 v65, v21, v141
    v_fmac_f32 v66, v21, v142
    v_fmac_f32 v67, v21, v143
    v_fmac_f32 v68, v21, v144
    v_fmac_f32 v69, v21, v145
    v_fmac_f32 v70, v21, v146
    v_fmac_f32 v71, v21, v147
    v_cvt_pk_bf16_f32 v28, v64, v65
    v_cvt_pk_bf16_f32 v29, v66, v67
    v_cvt_pk_bf16_f32 v30, v68, v69
    v_cvt_pk_bf16_f32 v31, v70, v71
    buffer_store_dwordx4 v[28:31], v2, s[28:31], s53 offen sc1
    s_cmp_eq_u32 s55, 0
    s_cbranch_scc1 LOB_LATE
    s_waitcnt vmcnt(2)
    s_branch PHASE3
GEMM:
    s_getpc_b64 s[88:89]
CPF_PC:
    s_sub_u32 s88, s88, CPF_PC-gated_mix__mha_block__sliding_local_dilated__prompt_kernel
    s_subb_u32 s89, s89, 0
    s_lshl_b32 s90, s48, 2
    s_add_u32 s90, s90, s44
    s_mul_i32 s90, s90, 320
    s_min_u32 s90, s90, K_LAST-gated_mix__mha_block__sliding_local_dilated__prompt_kernel-320
    s_add_u32 s88, s88, s90
    s_addc_u32 s89, s89, 0
    s_load_dword s91, s[88:89], 0
    s_load_dword s24, s[88:89], 64
    s_load_dword s25, s[88:89], 128
    s_load_dword s26, s[88:89], 192
    s_load_dword s27, s[88:89], 256
    s_lshr_b32 s92, s44, 1
    s_and_b32 s93, s44, 1
    v_bfe_u32 v19, v1, 1, 3
    v_xor_b32 v19, v19, v4
    s_lshl_b32 s47, s92, 5
    v_add_u32 v12, s47, v5
    v_lshlrev_b32 v12, 7, v12
    v_xor_b32 v13, 0, v19
    v_lshl_add_u32 v8, v13, 4, v12
    v_xor_b32 v13, 2, v19
    v_lshl_add_u32 v9, v13, 4, v12
    v_xor_b32 v13, 4, v19
    v_lshl_add_u32 v10, v13, 4, v12
    v_xor_b32 v13, 6, v19
    v_lshl_add_u32 v11, v13, 4, v12
    v_bfe_u32 v12, v1, 2, 2
    v_lshl_add_u32 v13, v4, 3, v12
    v_lshlrev_b32 v13, 7, v13
    v_bfe_u32 v14, v1, 4, 1
    v_lshlrev_b32 v14, 1, v14
    v_bfe_u32 v15, v1, 1, 1
    v_add_u32 v14, v14, v15
    v_bfe_u32 v15, v1, 3, 1
    v_xor_b32 v15, s93, v15
    v_lshl_add_u32 v14, v15, 2, v14
    v_lshl_add_u32 v13, v14, 4, v13
    v_and_b32 v15, 1, v1
    v_lshl_add_u32 v24, v15, 3, v13
    v_add_u32 v25, 0xc000, v24
    v_add_u32 v26, 0x18000, v24
    v_add_u32 v27, 0x24000, v24
    s_lshl_b32 s10, s40, 1
    s_add_u32 s10, s10, s92
    s_lshl_b32 s11, s41, 1
    s_add_u32 s11, s11, s93
    s_lshl_b32 s82, s11, 18
    s_lshl_b32 s83, s10, 11
    s_add_u32 s82, s82, s83
    s_add_u32 s83, s82, 0x20000
    s_lshl_b32 s80, s93, 12
    s_lshl_b32 s47, s92, 10
    s_add_u32 s80, s80, s47
    s_add_u32 s80, s80, 57344
    v_bfe_u32 v12, v1, 4, 1
    v_lshlrev_b32 v12, 17, v12
    v_lshl_add_u32 v12, v4, 8, v12
    v_and_b32 v13, 15, v1
    v_lshl_add_u32 v16, v13, 4, v12
    s_mov_b32 s85, 0x3eb8aa3b
    s_lshl_b32 s47, s11, 6
    s_add_u32 s47, s47, s10
    s_lshl_b32 s86, s47, 7
    s_add_u32 s86, s86, 0x1020000
    s_add_u32 s3, s86, 0x20000
    s_lshl_b32 s87, s47, 12
    s_add_u32 s87, s87, 0x600000
    s_cmp_eq_u32 s10, 0
    s_cselect_b32 s47, 0, 4096
    s_sub_u32 s79, s87, s47
    s_lshl_b32 s75, s10, 8
    s_add_u32 s75, s75, 0x100c000
    s_mov_b64 s[94:95], 0
    v_mov_b32 v42, 65536
    v_mov_b32 v43, 1
    v_and_b32 v3, 15, v1
    v_lshlrev_b32 v3, 4, v3
    v_lshl_add_u32 v3, v4, 8, v3
    v_and_b32 v6, 0x33, v1
    v_bfe_u32 v7, v1, 2, 1
    v_lshl_add_u32 v6, v7, 3, v6
    v_bfe_u32 v7, v1, 3, 1
    v_lshl_add_u32 v6, v7, 2, v6
    v_lshlrev_b32 v6, 4, v6
    s_lshl_b32 s45, s40, 1
    s_lshl_b32 s62, s41, 2
    s_add_u32 s62, s62, s44
    v_min_u32 v17, 31, v1
    v_lshlrev_b32 v17, 7, v17
    s_lshr_b32 s48, s62, 1
    s_lshl_b32 s48, s48, 13
    s_add_u32 s48, s48, 0x1020000
    s_lshl_b32 s52, s62, 17
    s_add_u32 s52, s52, 0x0
    s_lshl_b32 s49, s44, 11
    s_add_u32 s49, s49, 57344
    s_mov_b32 s60, 0x0000ffff
    s_mov_b32 s61, 0x0000ffff
    v_and_b32 v30, 27, v1
    v_cmp_eq_u32 vcc, 16, v30
    v_mov_b32 v7, 0x3f803f80
    s_lshl_b32 s58, s44, 14
    v_cndmask_b32 v30, 0, v7, vcc
    v_mov_b32 v7, 0xdddddddd
    s_add_u32 s58, s58, 0
    s_lshl_b32 s59, s44, 17
    s_lshl_b32 s51, s42, 7
    s_add_u32 s59, s59, s51
    s_mov_b32 s56, 0
    s_and_b32 s64, s63, 1
    s_lshr_b32 s65, s63, 1
    s_lshl_b32 s66, s43, 1
    s_add_u32 s66, s66, s64
    s_lshl_b32 s74, s45, 8
    s_add_u32 s74, s74, 0x100c000
    s_lshl_b32 s67, s66, 6
    s_lshl_b32 s68, s65, 3
    s_add_u32 s67, s67, s68
    s_lshl_b32 s67, s67, 10
    s_add_u32 s67, s67, 0xc00000
    s_add_u32 s70, s67, 4096
    s_add_u32 s68, s67, 0x8000
    s_add_u32 s71, s68, 4096
    s_lshl_b32 s69, s66, 4
    s_lshl_b32 s47, s65, 2
    s_add_u32 s69, s69, s47
    s_lshl_b32 s69, s69, 7
    s_add_u32 s69, s69, 0x1060000
    s_lshl_b32 s73, s45, 6
    s_add_u32 s73, s73, s62
    s_lshl_b32 s73, s73, 10
    s_add_u32 s73, s73, 0xc00000
    s_add_u32 s53, s73, 0x10000
    s_lshl_b32 s72, s66, 15
    s_add_u32 s72, s72, s51
    s_lshr_b32 s47, s65, 1
    s_lshl_b32 s47, s47, 6
    s_add_u32 s72, s72, s47
    s_and_b32 s47, s65, 1
    s_lshl_b32 s47, s47, 4
    s_add_u32 s72, s72, s47
    s_waitcnt lgkmcnt(0)
    s_mov_b32 s28, s38
    s_mov_b32 s29, s39
    s_mov_b32 s30, 0x10000000
    s_mov_b32 s31, 0x20000
    s_mov_b32 s32, s36
    s_mov_b32 s33, s37
    s_mov_b32 s34, 0x100
    s_mov_b32 s35, 0x20000
    s_mov_b32 s20, s8
    s_mov_b32 s21, s9
    s_mov_b32 s22, 0x80000
    s_mov_b32 s23, 0x20000
    s_setprio 3
    s_barrier
    ds_read_b128 v[128:131], v8 offset:0
    ds_read_b64_tr_b16 v[44:45], v24 offset:8192
    ds_read_b64_tr_b16 v[46:47], v24 offset:8704
    ds_read_b64_tr_b16 v[48:49], v24 offset:16384
    ds_read_b64_tr_b16 v[50:51], v24 offset:16896
    ds_read_b128 v[132:135], v9 offset:0
    ds_read_b64_tr_b16 v[52:53], v24 offset:10240
    ds_read_b64_tr_b16 v[54:55], v24 offset:10752
    ds_read_b64_tr_b16 v[56:57], v24 offset:18432
    ds_read_b64_tr_b16 v[58:59], v24 offset:18944
    s_waitcnt lgkmcnt(5)
    v_mfma_f32_32x32x16_bf16 v[96:111], v[44:47], v[128:131], 0
    ds_read_b128 v[136:139], v10 offset:0
    ds_read_b64_tr_b16 v[60:61], v24 offset:12288
    ds_read_b64_tr_b16 v[62:63], v24 offset:12800
    v_mfma_f32_32x32x16_bf16 v[112:127], v[128:131], v[48:51], 0
    ds_read_b64_tr_b16 v[64:65], v24 offset:20480
    ds_read_b64_tr_b16 v[66:67], v24 offset:20992
    s_waitcnt lgkmcnt(5)
    v_mfma_f32_32x32x16_bf16 v[96:111], v[52:55], v[132:135], v[96:111]
    ds_read_b128 v[140:143], v11 offset:0
    ds_read_b64_tr_b16 v[68:69], v24 offset:14336
    ds_read_b64_tr_b16 v[70:71], v24 offset:14848
    v_mfma_f32_32x32x16_bf16 v[112:127], v[132:135], v[56:59], v[112:127]
    ds_read_b64_tr_b16 v[72:73], v24 offset:22528
    ds_read_b64_tr_b16 v[74:75], v24 offset:23040
    s_waitcnt lgkmcnt(0)
    s_barrier
    v_mfma_f32_32x32x16_bf16 v[96:111], v[60:63], v[136:139], v[96:111]
    ds_read_b128 v[144:147], v8 offset:24576
    ds_read_b64_tr_b16 v[44:45], v24 offset:32768
    ds_read_b64_tr_b16 v[46:47], v24 offset:33280
    v_mfma_f32_32x32x16_bf16 v[112:127], v[136:139], v[64:67], v[112:127]
    ds_read_b64_tr_b16 v[48:49], v24 offset:40960
    ds_read_b64_tr_b16 v[50:51], v24 offset:41472
    v_mfma_f32_32x32x16_bf16 v[96:111], v[68:71], v[140:143], v[96:111]
    ds_read_b128 v[148:151], v9 offset:24576
    ds_read_b64_tr_b16 v[52:53], v24 offset:34816
    ds_read_b64_tr_b16 v[54:55], v24 offset:35328
    v_mfma_f32_32x32x16_bf16 v[112:127], v[140:143], v[72:75], v[112:127]
    ds_read_b64_tr_b16 v[56:57], v24 offset:43008
    ds_read_b64_tr_b16 v[58:59], v24 offset:43520
    s_waitcnt lgkmcnt(5)
    v_mfma_f32_32x32x16_bf16 v[96:111], v[44:47], v[144:147], v[96:111]
    ds_read_b128 v[152:155], v10 offset:24576
    ds_read_b64_tr_b16 v[60:61], v24 offset:36864
    ds_read_b64_tr_b16 v[62:63], v24 offset:37376
    v_mfma_f32_32x32x16_bf16 v[112:127], v[144:147], v[48:51], v[112:127]
    ds_read_b64_tr_b16 v[64:65], v24 offset:45056
    ds_read_b64_tr_b16 v[66:67], v24 offset:45568
    s_waitcnt lgkmcnt(5)
    v_mfma_f32_32x32x16_bf16 v[96:111], v[52:55], v[148:151], v[96:111]
    ds_read_b128 v[156:159], v11 offset:24576
    ds_read_b64_tr_b16 v[68:69], v24 offset:38912
    ds_read_b64_tr_b16 v[70:71], v24 offset:39424
    v_mfma_f32_32x32x16_bf16 v[112:127], v[148:151], v[56:59], v[112:127]
    ds_read_b64_tr_b16 v[72:73], v24 offset:47104
    ds_read_b64_tr_b16 v[74:75], v24 offset:47616
    s_waitcnt lgkmcnt(0)
    s_barrier
    v_mfma_f32_32x32x16_bf16 v[96:111], v[60:63], v[152:155], v[96:111]
    ds_read_b128 v[160:163], v8 offset:49152
    ds_read_b64_tr_b16 v[44:45], v25 offset:8192
    ds_read_b64_tr_b16 v[46:47], v25 offset:8704
    v_mfma_f32_32x32x16_bf16 v[112:127], v[152:155], v[64:67], v[112:127]
    ds_read_b64_tr_b16 v[48:49], v25 offset:16384
    ds_read_b64_tr_b16 v[50:51], v25 offset:16896
    v_mfma_f32_32x32x16_bf16 v[96:111], v[68:71], v[156:159], v[96:111]
    ds_read_b128 v[164:167], v9 offset:49152
    ds_read_b64_tr_b16 v[52:53], v25 offset:10240
    ds_read_b64_tr_b16 v[54:55], v25 offset:10752
    v_mfma_f32_32x32x16_bf16 v[112:127], v[156:159], v[72:75], v[112:127]
    ds_read_b64_tr_b16 v[56:57], v25 offset:18432
    ds_read_b64_tr_b16 v[58:59], v25 offset:18944
    s_waitcnt lgkmcnt(5)
    v_mfma_f32_32x32x16_bf16 v[96:111], v[44:47], v[160:163], v[96:111]
    ds_read_b128 v[168:171], v10 offset:49152
    ds_read_b64_tr_b16 v[60:61], v25 offset:12288
    ds_read_b64_tr_b16 v[62:63], v25 offset:12800
    v_mfma_f32_32x32x16_bf16 v[112:127], v[160:163], v[48:51], v[112:127]
    ds_read_b64_tr_b16 v[64:65], v25 offset:20480
    ds_read_b64_tr_b16 v[66:67], v25 offset:20992
    s_waitcnt lgkmcnt(5)
    v_mfma_f32_32x32x16_bf16 v[96:111], v[52:55], v[164:167], v[96:111]
    ds_read_b128 v[172:175], v11 offset:49152
    ds_read_b64_tr_b16 v[68:69], v25 offset:14336
    ds_read_b64_tr_b16 v[70:71], v25 offset:14848
    v_mfma_f32_32x32x16_bf16 v[112:127], v[164:167], v[56:59], v[112:127]
    ds_read_b64_tr_b16 v[72:73], v25 offset:22528
    ds_read_b64_tr_b16 v[74:75], v25 offset:23040
    s_waitcnt lgkmcnt(0)
    s_barrier
    v_mfma_f32_32x32x16_bf16 v[96:111], v[60:63], v[168:171], v[96:111]
    ds_read_b128 v[176:179], v8 offset:0
    ds_read_b64_tr_b16 v[44:45], v24 offset:8192
    ds_read_b64_tr_b16 v[46:47], v24 offset:8704
    v_mfma_f32_32x32x16_bf16 v[112:127], v[168:171], v[64:67], v[112:127]
    ds_read_b64_tr_b16 v[48:49], v24 offset:16384
    ds_read_b64_tr_b16 v[50:51], v24 offset:16896
    v_mfma_f32_32x32x16_bf16 v[96:111], v[68:71], v[172:175], v[96:111]
    ds_read_b128 v[180:183], v9 offset:0
    ds_read_b64_tr_b16 v[52:53], v24 offset:10240
    ds_read_b64_tr_b16 v[54:55], v24 offset:10752
    v_mfma_f32_32x32x16_bf16 v[112:127], v[172:175], v[72:75], v[112:127]
    ds_read_b64_tr_b16 v[56:57], v24 offset:18432
    ds_read_b64_tr_b16 v[58:59], v24 offset:18944
    s_waitcnt lgkmcnt(5)
    v_mfma_f32_32x32x16_bf16 v[96:111], v[44:47], v[176:179], v[96:111]
    ds_read_b128 v[184:187], v10 offset:0
    ds_read_b64_tr_b16 v[60:61], v24 offset:12288
    ds_read_b64_tr_b16 v[62:63], v24 offset:12800
    v_mfma_f32_32x32x16_bf16 v[112:127], v[176:179], v[48:51], v[112:127]
    ds_read_b64_tr_b16 v[64:65], v24 offset:20480
    ds_read_b64_tr_b16 v[66:67], v24 offset:20992
    s_waitcnt lgkmcnt(5)
    v_mfma_f32_32x32x16_bf16 v[96:111], v[52:55], v[180:183], v[96:111]
    ds_read_b128 v[188:191], v11 offset:0
    ds_read_b64_tr_b16 v[68:69], v24 offset:14336
    ds_read_b64_tr_b16 v[70:71], v24 offset:14848
    v_mfma_f32_32x32x16_bf16 v[112:127], v[180:183], v[56:59], v[112:127]
    ds_read_b64_tr_b16 v[72:73], v24 offset:22528
    ds_read_b64_tr_b16 v[74:75], v24 offset:23040
    s_waitcnt lgkmcnt(0)
    s_barrier
    v_mfma_f32_32x32x16_bf16 v[96:111], v[60:63], v[184:187], v[96:111]
    ds_read_b128 v[192:195], v8 offset:24576
    ds_read_b64_tr_b16 v[44:45], v24 offset:32768
    ds_read_b64_tr_b16 v[46:47], v24 offset:33280
    v_mfma_f32_32x32x16_bf16 v[112:127], v[184:187], v[64:67], v[112:127]
    ds_read_b64_tr_b16 v[48:49], v24 offset:40960
    ds_read_b64_tr_b16 v[50:51], v24 offset:41472
    v_mfma_f32_32x32x16_bf16 v[96:111], v[68:71], v[188:191], v[96:111]
    ds_read_b128 v[196:199], v9 offset:24576
    ds_read_b64_tr_b16 v[52:53], v24 offset:34816
    ds_read_b64_tr_b16 v[54:55], v24 offset:35328
    v_mfma_f32_32x32x16_bf16 v[112:127], v[188:191], v[72:75], v[112:127]
    ds_read_b64_tr_b16 v[56:57], v24 offset:43008
    ds_read_b64_tr_b16 v[58:59], v24 offset:43520
    s_waitcnt lgkmcnt(5)
    v_mfma_f32_32x32x16_bf16 v[96:111], v[44:47], v[192:195], v[96:111]
    ds_read_b128 v[200:203], v10 offset:24576
    ds_read_b64_tr_b16 v[60:61], v24 offset:36864
    ds_read_b64_tr_b16 v[62:63], v24 offset:37376
    v_mfma_f32_32x32x16_bf16 v[112:127], v[192:195], v[48:51], v[112:127]
    ds_read_b64_tr_b16 v[64:65], v24 offset:45056
    ds_read_b64_tr_b16 v[66:67], v24 offset:45568
    s_waitcnt lgkmcnt(5)
    v_mfma_f32_32x32x16_bf16 v[96:111], v[52:55], v[196:199], v[96:111]
    ds_read_b128 v[204:207], v11 offset:24576
    ds_read_b64_tr_b16 v[68:69], v24 offset:38912
    ds_read_b64_tr_b16 v[70:71], v24 offset:39424
    v_mfma_f32_32x32x16_bf16 v[112:127], v[196:199], v[56:59], v[112:127]
    ds_read_b64_tr_b16 v[72:73], v24 offset:47104
    ds_read_b64_tr_b16 v[74:75], v24 offset:47616
    s_waitcnt lgkmcnt(0)
    s_barrier
    v_mfma_f32_32x32x16_bf16 v[96:111], v[60:63], v[200:203], v[96:111]
    ds_read_b128 v[208:211], v8 offset:49152
    ds_read_b64_tr_b16 v[44:45], v25 offset:8192
    ds_read_b64_tr_b16 v[46:47], v25 offset:8704
    v_mfma_f32_32x32x16_bf16 v[112:127], v[200:203], v[64:67], v[112:127]
    ds_read_b64_tr_b16 v[48:49], v25 offset:16384
    ds_read_b64_tr_b16 v[50:51], v25 offset:16896
    v_mfma_f32_32x32x16_bf16 v[96:111], v[68:71], v[204:207], v[96:111]
    ds_read_b128 v[212:215], v9 offset:49152
    ds_read_b64_tr_b16 v[52:53], v25 offset:10240
    ds_read_b64_tr_b16 v[54:55], v25 offset:10752
    v_mfma_f32_32x32x16_bf16 v[112:127], v[204:207], v[72:75], v[112:127]
    ds_read_b64_tr_b16 v[56:57], v25 offset:18432
    ds_read_b64_tr_b16 v[58:59], v25 offset:18944
    s_waitcnt lgkmcnt(5)
    v_mfma_f32_32x32x16_bf16 v[96:111], v[44:47], v[208:211], v[96:111]
    ds_read_b128 v[216:219], v10 offset:49152
    ds_read_b64_tr_b16 v[60:61], v25 offset:12288
    ds_read_b64_tr_b16 v[62:63], v25 offset:12800
    v_mfma_f32_32x32x16_bf16 v[112:127], v[208:211], v[48:51], v[112:127]
    ds_read_b64_tr_b16 v[64:65], v25 offset:20480
    ds_read_b64_tr_b16 v[66:67], v25 offset:20992
    s_waitcnt lgkmcnt(5)
    v_mfma_f32_32x32x16_bf16 v[96:111], v[52:55], v[212:215], v[96:111]
    ds_read_b128 v[220:223], v11 offset:49152
    ds_read_b64_tr_b16 v[68:69], v25 offset:14336
    ds_read_b64_tr_b16 v[70:71], v25 offset:14848
    v_mfma_f32_32x32x16_bf16 v[112:127], v[212:215], v[56:59], v[112:127]
    ds_read_b64_tr_b16 v[72:73], v25 offset:22528
    ds_read_b64_tr_b16 v[74:75], v25 offset:23040
    s_waitcnt lgkmcnt(5)
    s_barrier
    v_mfma_f32_32x32x16_bf16 v[96:111], v[60:63], v[216:219], v[96:111]
    ds_read_b128 v[224:227], v8 offset:0
    ds_read_b64_tr_b16 v[44:45], v24 offset:8192
    ds_read_b64_tr_b16 v[46:47], v24 offset:8704
    v_mfma_f32_32x32x16_bf16 v[112:127], v[216:219], v[64:67], v[112:127]
    ds_read_b64_tr_b16 v[48:49], v24 offset:16384
    ds_read_b64_tr_b16 v[50:51], v24 offset:16896
    s_waitcnt lgkmcnt(5)
    v_mfma_f32_32x32x16_bf16 v[96:111], v[68:71], v[220:223], v[96:111]
    ds_read_b128 v[228:231], v9 offset:0
    ds_read_b64_tr_b16 v[52:53], v24 offset:10240
    ds_read_b64_tr_b16 v[54:55], v24 offset:10752
    v_mfma_f32_32x32x16_bf16 v[112:127], v[220:223], v[72:75], v[112:127]
    ds_read_b64_tr_b16 v[56:57], v24 offset:18432
    ds_read_b64_tr_b16 v[58:59], v24 offset:18944
    s_waitcnt lgkmcnt(5)
    v_mfma_f32_32x32x16_bf16 v[96:111], v[44:47], v[224:227], v[96:111]
    ds_read_b128 v[232:235], v10 offset:0
    ds_read_b64_tr_b16 v[60:61], v24 offset:12288
    ds_read_b64_tr_b16 v[62:63], v24 offset:12800
    v_mfma_f32_32x32x16_bf16 v[112:127], v[224:227], v[48:51], v[112:127]
    ds_read_b64_tr_b16 v[64:65], v24 offset:20480
    ds_read_b64_tr_b16 v[66:67], v24 offset:20992
    s_waitcnt lgkmcnt(5)
    v_mfma_f32_32x32x16_bf16 v[96:111], v[52:55], v[228:231], v[96:111]
    ds_read_b128 v[236:239], v11 offset:0
    ds_read_b64_tr_b16 v[68:69], v24 offset:14336
    ds_read_b64_tr_b16 v[70:71], v24 offset:14848
    v_mfma_f32_32x32x16_bf16 v[112:127], v[228:231], v[56:59], v[112:127]
    ds_read_b64_tr_b16 v[72:73], v24 offset:22528
    ds_read_b64_tr_b16 v[74:75], v24 offset:23040
    s_waitcnt lgkmcnt(5)
    s_barrier
    v_mfma_f32_32x32x16_bf16 v[96:111], v[60:63], v[232:235], v[96:111]
    ds_read_b128 v[240:243], v8 offset:24576
    ds_read_b64_tr_b16 v[44:45], v24 offset:32768
    ds_read_b64_tr_b16 v[46:47], v24 offset:33280
    v_mfma_f32_32x32x16_bf16 v[112:127], v[232:235], v[64:67], v[112:127]
    ds_read_b64_tr_b16 v[48:49], v24 offset:40960
    ds_read_b64_tr_b16 v[50:51], v24 offset:41472
    s_waitcnt lgkmcnt(5)
    v_mfma_f32_32x32x16_bf16 v[96:111], v[68:71], v[236:239], v[96:111]
    ds_read_b128 v[244:247], v9 offset:24576
    ds_read_b64_tr_b16 v[52:53], v24 offset:34816
    ds_read_b64_tr_b16 v[54:55], v24 offset:35328
    v_mfma_f32_32x32x16_bf16 v[112:127], v[236:239], v[72:75], v[112:127]
    ds_read_b64_tr_b16 v[56:57], v24 offset:43008
    ds_read_b64_tr_b16 v[58:59], v24 offset:43520
    s_waitcnt lgkmcnt(5)
    v_mfma_f32_32x32x16_bf16 v[96:111], v[44:47], v[240:243], v[96:111]
    ds_read_b128 v[248:251], v10 offset:24576
    ds_read_b64_tr_b16 v[60:61], v24 offset:36864
    ds_read_b64_tr_b16 v[62:63], v24 offset:37376
    v_mfma_f32_32x32x16_bf16 v[112:127], v[240:243], v[48:51], v[112:127]
    ds_read_b64_tr_b16 v[64:65], v24 offset:45056
    ds_read_b64_tr_b16 v[66:67], v24 offset:45568
    s_waitcnt lgkmcnt(5)
    v_mfma_f32_32x32x16_bf16 v[96:111], v[52:55], v[244:247], v[96:111]
    ds_read_b128 v[252:255], v11 offset:24576
    ds_read_b64_tr_b16 v[68:69], v24 offset:38912
    ds_read_b64_tr_b16 v[70:71], v24 offset:39424
    v_mfma_f32_32x32x16_bf16 v[112:127], v[244:247], v[56:59], v[112:127]
    ds_read_b64_tr_b16 v[72:73], v24 offset:47104
    ds_read_b64_tr_b16 v[74:75], v24 offset:47616
    s_waitcnt lgkmcnt(5)
    v_mfma_f32_32x32x16_bf16 v[96:111], v[60:63], v[248:251], v[96:111]
    v_mfma_f32_32x32x16_bf16 v[112:127], v[248:251], v[64:67], v[112:127]
    s_waitcnt lgkmcnt(0)
    v_mfma_f32_32x32x16_bf16 v[96:111], v[68:71], v[252:255], v[96:111]
    v_mfma_f32_32x32x16_bf16 v[112:127], v[252:255], v[72:75], v[112:127]
    s_nop 10
    v_cvt_pk_bf16_f32 v32, v96, v97
    v_cvt_pk_bf16_f32 v33, v98, v99
    v_cvt_pk_bf16_f32 v34, v100, v101
    v_cvt_pk_bf16_f32 v35, v102, v103
    buffer_store_dwordx4 v[32:35], v2, s[28:31], s82 offen sc1
    v_cvt_pk_bf16_f32 v36, v104, v105
    v_cvt_pk_bf16_f32 v37, v106, v107
    v_cvt_pk_bf16_f32 v38, v108, v109
    v_cvt_pk_bf16_f32 v39, v110, v111
    buffer_store_dwordx4 v[36:39], v2, s[28:31], s83 offen sc1
    v_cvt_pk_bf16_f32 v8, v112, v113
    v_cvt_pk_bf16_f32 v9, v114, v115
    v_cvt_pk_bf16_f32 v10, v116, v117
    v_cvt_pk_bf16_f32 v11, v118, v119
    buffer_store_dwordx4 v[8:11], v16, s[28:31], s82 offen offset:1024 sc1
    v_cvt_pk_bf16_f32 v12, v120, v121
    v_cvt_pk_bf16_f32 v13, v122, v123
    v_cvt_pk_bf16_f32 v14, v124, v125
    v_cvt_pk_bf16_f32 v15, v126, v127
    buffer_store_dwordx4 v[12:15], v16, s[28:31], s82 offen offset:1536 sc1
    buffer_load_dwordx2 v[28:29], v31, s[32:35], 0 offen sc1
    s_barrier
    v_lshl_add_u32 v18, v1, 2, v42
    s_mov_b64 exec, 0xff
    ds_write_b32 v18, v31
    s_mov_b64 exec, -1
    ds_read_b64_tr_b16 v[44:45], v26 offset:0
    ds_read_b64_tr_b16 v[46:47], v26 offset:512
    ds_read_b64_tr_b16 v[48:49], v26 offset:2048
    ds_read_b64_tr_b16 v[50:51], v26 offset:2560
    ds_read_b64_tr_b16 v[52:53], v26 offset:4096
    ds_read_b64_tr_b16 v[54:55], v26 offset:4608
    ds_read_b64_tr_b16 v[56:57], v26 offset:6144
    ds_read_b64_tr_b16 v[58:59], v26 offset:6656
    ds_read_b64_tr_b16 v[60:61], v26 offset:8192
    ds_read_b64_tr_b16 v[62:63], v26 offset:8704
    ds_read_b64_tr_b16 v[64:65], v26 offset:10240
    ds_read_b64_tr_b16 v[66:67], v26 offset:10752
    s_waitcnt lgkmcnt(10)
    v_mfma_f32_32x32x16_bf16 v[80:95], v[44:47], v[128:131], 0
    ds_read_b64_tr_b16 v[68:69], v26 offset:12288
    ds_read_b64_tr_b16 v[70:71], v26 offset:12800
    s_waitcnt lgkmcnt(10)
    v_mfma_f32_32x32x16_bf16 v[80:95], v[48:51], v[132:135], v[80:95]
    ds_read_b64_tr_b16 v[72:73], v26 offset:14336
    ds_read_b64_tr_b16 v[74:75], v26 offset:14848
    s_waitcnt lgkmcnt(10)
    v_mfma_f32_32x32x16_bf16 v[80:95], v[52:55], v[136:139], v[80:95]
    ds_read_b64_tr_b16 v[76:77], v26 offset:16384
    ds_read_b64_tr_b16 v[78:79], v26 offset:16896
    s_waitcnt lgkmcnt(10)
    v_mfma_f32_32x32x16_bf16 v[80:95], v[56:59], v[140:143], v[80:95]
    ds_read_b64_tr_b16 v[44:45], v26 offset:18432
    ds_read_b64_tr_b16 v[46:47], v26 offset:18944
    s_waitcnt lgkmcnt(10)
    v_mfma_f32_32x32x16_bf16 v[80:95], v[60:63], v[144:147], v[80:95]
    ds_read_b64_tr_b16 v[48:49], v26 offset:20480
    ds_read_b64_tr_b16 v[50:51], v26 offset:20992
    s_waitcnt lgkmcnt(10)
    v_mfma_f32_32x32x16_bf16 v[80:95], v[64:67], v[148:151], v[80:95]
    ds_read_b64_tr_b16 v[52:53], v26 offset:22528
    ds_read_b64_tr_b16 v[54:55], v26 offset:23040
    s_waitcnt lgkmcnt(10)
    v_mfma_f32_32x32x16_bf16 v[80:95], v[68:71], v[152:155], v[80:95]
    ds_read_b64_tr_b16 v[56:57], v26 offset:24576
    ds_read_b64_tr_b16 v[58:59], v26 offset:25088
    s_waitcnt lgkmcnt(10)
    v_mfma_f32_32x32x16_bf16 v[80:95], v[72:75], v[156:159], v[80:95]
    ds_read_b64_tr_b16 v[60:61], v26 offset:26624
    ds_read_b64_tr_b16 v[62:63], v26 offset:27136
    s_waitcnt lgkmcnt(10)
    v_mfma_f32_32x32x16_bf16 v[80:95], v[76:79], v[160:163], v[80:95]
    ds_read_b64_tr_b16 v[64:65], v26 offset:28672
    ds_read_b64_tr_b16 v[66:67], v26 offset:29184
    s_waitcnt lgkmcnt(10)
    v_mfma_f32_32x32x16_bf16 v[80:95], v[44:47], v[164:167], v[80:95]
    ds_read_b64_tr_b16 v[68:69], v26 offset:30720
    ds_read_b64_tr_b16 v[70:71], v26 offset:31232
    s_waitcnt lgkmcnt(10)
    v_mfma_f32_32x32x16_bf16 v[80:95], v[48:51], v[168:171], v[80:95]
    ds_read_b64_tr_b16 v[72:73], v26 offset:32768
    ds_read_b64_tr_b16 v[74:75], v26 offset:33280
    s_waitcnt lgkmcnt(10)
    v_mfma_f32_32x32x16_bf16 v[80:95], v[52:55], v[172:175], v[80:95]
    ds_read_b64_tr_b16 v[76:77], v26 offset:34816
    ds_read_b64_tr_b16 v[78:79], v26 offset:35328
    s_waitcnt lgkmcnt(10)
    v_mfma_f32_32x32x16_bf16 v[80:95], v[56:59], v[176:179], v[80:95]
    ds_read_b64_tr_b16 v[44:45], v26 offset:36864
    ds_read_b64_tr_b16 v[46:47], v26 offset:37376
    s_waitcnt lgkmcnt(10)
    v_mfma_f32_32x32x16_bf16 v[80:95], v[60:63], v[180:183], v[80:95]
    ds_read_b64_tr_b16 v[48:49], v26 offset:38912
    ds_read_b64_tr_b16 v[50:51], v26 offset:39424
    s_waitcnt lgkmcnt(10)
    v_mfma_f32_32x32x16_bf16 v[80:95], v[64:67], v[184:187], v[80:95]
    ds_read_b64_tr_b16 v[52:53], v26 offset:40960
    ds_read_b64_tr_b16 v[54:55], v26 offset:41472
    s_waitcnt lgkmcnt(10)
    v_mfma_f32_32x32x16_bf16 v[80:95], v[68:71], v[188:191], v[80:95]
    ds_read_b64_tr_b16 v[56:57], v26 offset:43008
    ds_read_b64_tr_b16 v[58:59], v26 offset:43520
    s_waitcnt lgkmcnt(10)
    v_mfma_f32_32x32x16_bf16 v[80:95], v[72:75], v[192:195], v[80:95]
    ds_read_b64_tr_b16 v[60:61], v26 offset:45056
    ds_read_b64_tr_b16 v[62:63], v26 offset:45568
    s_waitcnt lgkmcnt(10)
    v_mfma_f32_32x32x16_bf16 v[80:95], v[76:79], v[196:199], v[80:95]
    ds_read_b64_tr_b16 v[64:65], v26 offset:47104
    ds_read_b64_tr_b16 v[66:67], v26 offset:47616
    s_waitcnt lgkmcnt(10)
    v_mfma_f32_32x32x16_bf16 v[80:95], v[44:47], v[200:203], v[80:95]
    ds_read_b64_tr_b16 v[68:69], v27 offset:0
    ds_read_b64_tr_b16 v[70:71], v27 offset:512
    s_waitcnt lgkmcnt(10)
    v_mfma_f32_32x32x16_bf16 v[80:95], v[48:51], v[204:207], v[80:95]
    ds_read_b64_tr_b16 v[72:73], v27 offset:2048
    ds_read_b64_tr_b16 v[74:75], v27 offset:2560
    s_waitcnt lgkmcnt(10)
    v_mfma_f32_32x32x16_bf16 v[80:95], v[52:55], v[208:211], v[80:95]
    ds_read_b64_tr_b16 v[76:77], v27 offset:4096
    ds_read_b64_tr_b16 v[78:79], v27 offset:4608
    s_waitcnt lgkmcnt(10)
    v_mfma_f32_32x32x16_bf16 v[80:95], v[56:59], v[212:215], v[80:95]
    ds_read_b64_tr_b16 v[44:45], v27 offset:6144
    ds_read_b64_tr_b16 v[46:47], v27 offset:6656
    s_waitcnt lgkmcnt(10)
    v_mfma_f32_32x32x16_bf16 v[80:95], v[60:63], v[216:219], v[80:95]
    ds_read_b64_tr_b16 v[48:49], v27 offset:8192
    ds_read_b64_tr_b16 v[50:51], v27 offset:8704
    s_waitcnt lgkmcnt(10)
    v_mfma_f32_32x32x16_bf16 v[80:95], v[64:67], v[220:223], v[80:95]
    ds_read_b64_tr_b16 v[52:53], v27 offset:10240
    ds_read_b64_tr_b16 v[54:55], v27 offset:10752
    s_waitcnt lgkmcnt(10)
    v_mfma_f32_32x32x16_bf16 v[80:95], v[68:71], v[224:227], v[80:95]
    ds_read_b64_tr_b16 v[56:57], v27 offset:12288
    ds_read_b64_tr_b16 v[58:59], v27 offset:12800
    s_waitcnt lgkmcnt(10)
    v_mfma_f32_32x32x16_bf16 v[80:95], v[72:75], v[228:231], v[80:95]
    ds_read_b64_tr_b16 v[60:61], v27 offset:14336
    ds_read_b64_tr_b16 v[62:63], v27 offset:14848
    s_waitcnt lgkmcnt(10)
    v_mfma_f32_32x32x16_bf16 v[80:95], v[76:79], v[232:235], v[80:95]
    s_waitcnt lgkmcnt(8)
    v_mfma_f32_32x32x16_bf16 v[80:95], v[44:47], v[236:239], v[80:95]
    s_waitcnt lgkmcnt(6)
    v_mfma_f32_32x32x16_bf16 v[80:95], v[48:51], v[240:243], v[80:95]
    s_waitcnt lgkmcnt(4)
    v_mfma_f32_32x32x16_bf16 v[80:95], v[52:55], v[244:247], v[80:95]
    s_waitcnt lgkmcnt(2)
    v_mfma_f32_32x32x16_bf16 v[80:95], v[56:59], v[248:251], v[80:95]
    s_waitcnt lgkmcnt(0)
    v_mfma_f32_32x32x16_bf16 v[80:95], v[60:63], v[252:255], v[80:95]
    v_add_u32 v18, s80, v2
    s_nop 10
    v_mul_f32 v80, s85, v80
    v_mul_f32 v81, s85, v81
    v_mul_f32 v82, s85, v82
    v_mul_f32 v83, s85, v83
    v_mul_f32 v84, s85, v84
    v_mul_f32 v85, s85, v85
    v_mul_f32 v86, s85, v86
    v_mul_f32 v87, s85, v87
    v_cvt_pk_bf16_f32 v32, v80, v81
    v_cvt_pk_bf16_f32 v33, v82, v83
    v_cvt_pk_bf16_f32 v34, v84, v85
    v_cvt_pk_bf16_f32 v35, v86, v87
    ds_write_b128 v18, v[32:35] offset:0
    v_mul_f32 v88, s85, v88
    v_mul_f32 v89, s85, v89
    v_mul_f32 v90, s85, v90
    v_mul_f32 v91, s85, v91
    v_mul_f32 v92, s85, v92
    v_mul_f32 v93, s85, v93
    v_mul_f32 v94, s85, v94
    v_mul_f32 v95, s85, v95
    v_cvt_pk_bf16_f32 v36, v88, v89
    v_cvt_pk_bf16_f32 v37, v90, v91
    v_cvt_pk_bf16_f32 v38, v92, v93
    v_cvt_pk_bf16_f32 v39, v94, v95
    ds_write_b128 v18, v[36:39] offset:2048
    s_waitcnt lgkmcnt(0)
    s_barrier
    v_add_u32 v18, s49, v2
    ds_read_b128 v[8:11], v18 offset:0
    ds_read_b128 v[12:15], v18 offset:1024
    s_setprio 3
    ds_read_b64_tr_b16 v[44:45], v25 offset:24576
    ds_read_b64_tr_b16 v[46:47], v25 offset:25088
    ds_read_b64_tr_b16 v[48:49], v25 offset:32768
    ds_read_b64_tr_b16 v[50:51], v25 offset:33280
    ds_read_b64_tr_b16 v[52:53], v25 offset:40960
    ds_read_b64_tr_b16 v[54:55], v25 offset:41472
    ds_read_b64_tr_b16 v[56:57], v25 offset:26624
    ds_read_b64_tr_b16 v[58:59], v25 offset:27136
    ds_read_b64_tr_b16 v[60:61], v25 offset:34816
    ds_read_b64_tr_b16 v[62:63], v25 offset:35328
    ds_read_b64_tr_b16 v[64:65], v25 offset:43008
    ds_read_b64_tr_b16 v[66:67], v25 offset:43520
    s_waitcnt lgkmcnt(6)
    v_mfma_f32_32x32x16_bf16 v[80:95], v[44:47], v[128:131], 0
    ds_read_b64_tr_b16 v[68:69], v25 offset:28672
    ds_read_b64_tr_b16 v[70:71], v25 offset:29184
    v_mfma_f32_32x32x16_bf16 v[96:111], v[48:51], v[128:131], 0
    ds_read_b64_tr_b16 v[72:73], v25 offset:36864
    ds_read_b64_tr_b16 v[74:75], v25 offset:37376
    v_mfma_f32_32x32x16_bf16 v[112:127], v[128:131], v[52:55], 0
    ds_read_b64_tr_b16 v[76:77], v25 offset:45056
    ds_read_b64_tr_b16 v[78:79], v25 offset:45568
    s_waitcnt lgkmcnt(6)
    v_mfma_f32_32x32x16_bf16 v[80:95], v[56:59], v[132:135], v[80:95]
    ds_read_b64_tr_b16 v[44:45], v25 offset:30720
    ds_read_b64_tr_b16 v[46:47], v25 offset:31232
    v_mfma_f32_32x32x16_bf16 v[96:111], v[60:63], v[132:135], v[96:111]
    ds_read_b64_tr_b16 v[48:49], v25 offset:38912
    ds_read_b64_tr_b16 v[50:51], v25 offset:39424
    v_mfma_f32_32x32x16_bf16 v[112:127], v[132:135], v[64:67], v[112:127]
    ds_read_b64_tr_b16 v[52:53], v25 offset:47104
    ds_read_b64_tr_b16 v[54:55], v25 offset:47616
    s_waitcnt vmcnt(0)
    v_readfirstlane_b32 s76, v28
    v_readfirstlane_b32 s77, v29
    s_nop 1
    s_cmp_eq_u32 s76, 0
    s_cbranch_scc1 TAG6_S
TAGD6:
    v_mov_b32 v34, s76
    v_mov_b32 v35, s77
    v_mov_b32 v36, 0
    s_mov_b64 exec, 1
    buffer_store_dwordx2 v[34:35], v36, s[28:31], s86 offen sc1
    s_mov_b64 exec, -1
    s_waitcnt lgkmcnt(6)
    s_barrier
    v_mfma_f32_32x32x16_bf16 v[80:95], v[68:71], v[136:139], v[80:95]
    ds_read_b64_tr_b16 v[56:57], v24 offset:0
    ds_read_b64_tr_b16 v[58:59], v24 offset:512
    v_mfma_f32_32x32x16_bf16 v[96:111], v[72:75], v[136:139], v[96:111]
    ds_read_b64_tr_b16 v[60:61], v24 offset:8192
    ds_read_b64_tr_b16 v[62:63], v24 offset:8704
    v_mfma_f32_32x32x16_bf16 v[112:127], v[136:139], v[76:79], v[112:127]
    ds_read_b64_tr_b16 v[64:65], v24 offset:16384
    ds_read_b64_tr_b16 v[66:67], v24 offset:16896
    s_waitcnt lgkmcnt(6)
    v_mfma_f32_32x32x16_bf16 v[80:95], v[44:47], v[140:143], v[80:95]
    ds_read_b64_tr_b16 v[68:69], v24 offset:2048
    ds_read_b64_tr_b16 v[70:71], v24 offset:2560
    v_mfma_f32_32x32x16_bf16 v[96:111], v[48:51], v[140:143], v[96:111]
    ds_read_b64_tr_b16 v[72:73], v24 offset:10240
    ds_read_b64_tr_b16 v[74:75], v24 offset:10752
    v_mfma_f32_32x32x16_bf16 v[112:127], v[140:143], v[52:55], v[112:127]
    ds_read_b64_tr_b16 v[76:77], v24 offset:18432
    ds_read_b64_tr_b16 v[78:79], v24 offset:18944
    s_waitcnt lgkmcnt(6)
    v_mfma_f32_32x32x16_bf16 v[80:95], v[56:59], v[144:147], v[80:95]
    ds_read_b64_tr_b16 v[44:45], v24 offset:4096
    ds_read_b64_tr_b16 v[46:47], v24 offset:4608
    v_mfma_f32_32x32x16_bf16 v[96:111], v[60:63], v[144:147], v[96:111]
    ds_read_b64_tr_b16 v[48:49], v24 offset:12288
    ds_read_b64_tr_b16 v[50:51], v24 offset:12800
    v_mfma_f32_32x32x16_bf16 v[112:127], v[144:147], v[64:67], v[112:127]
    ds_read_b64_tr_b16 v[52:53], v24 offset:20480
    ds_read_b64_tr_b16 v[54:55], v24 offset:20992
    s_waitcnt lgkmcnt(6)
    v_mfma_f32_32x32x16_bf16 v[80:95], v[68:71], v[148:151], v[80:95]
    ds_read_b64_tr_b16 v[56:57], v24 offset:6144
    ds_read_b64_tr_b16 v[58:59], v24 offset:6656
    v_mfma_f32_32x32x16_bf16 v[96:111], v[72:75], v[148:151], v[96:111]
    ds_read_b64_tr_b16 v[60:61], v24 offset:14336
    ds_read_b64_tr_b16 v[62:63], v24 offset:14848
    v_mfma_f32_32x32x16_bf16 v[112:127], v[148:151], v[76:79], v[112:127]
    ds_read_b64_tr_b16 v[64:65], v24 offset:22528
    ds_read_b64_tr_b16 v[66:67], v24 offset:23040
    s_waitcnt lgkmcnt(6)
    s_barrier
    v_mfma_f32_32x32x16_bf16 v[80:95], v[44:47], v[152:155], v[80:95]
    ds_read_b64_tr_b16 v[68:69], v24 offset:24576
    ds_read_b64_tr_b16 v[70:71], v24 offset:25088
    v_mfma_f32_32x32x16_bf16 v[96:111], v[48:51], v[152:155], v[96:111]
    ds_read_b64_tr_b16 v[72:73], v24 offset:32768
    ds_read_b64_tr_b16 v[74:75], v24 offset:33280
    v_mfma_f32_32x32x16_bf16 v[112:127], v[152:155], v[52:55], v[112:127]
    ds_read_b64_tr_b16 v[76:77], v24 offset:40960
    ds_read_b64_tr_b16 v[78:79], v24 offset:41472
    s_waitcnt lgkmcnt(6)
    v_mfma_f32_32x32x16_bf16 v[80:95], v[56:59], v[156:159], v[80:95]
    ds_read_b64_tr_b16 v[44:45], v24 offset:26624
    ds_read_b64_tr_b16 v[46:47], v24 offset:27136
    v_mfma_f32_32x32x16_bf16 v[96:111], v[60:63], v[156:159], v[96:111]
    ds_read_b64_tr_b16 v[48:49], v24 offset:34816
    ds_read_b64_tr_b16 v[50:51], v24 offset:35328
    v_mfma_f32_32x32x16_bf16 v[112:127], v[156:159], v[64:67], v[112:127]
    ds_read_b64_tr_b16 v[52:53], v24 offset:43008
    ds_read_b64_tr_b16 v[54:55], v24 offset:43520
    s_waitcnt lgkmcnt(6)
    v_mfma_f32_32x32x16_bf16 v[80:95], v[68:71], v[160:163], v[80:95]
    ds_read_b64_tr_b16 v[56:57], v24 offset:28672
    ds_read_b64_tr_b16 v[58:59], v24 offset:29184
    v_mfma_f32_32x32x16_bf16 v[96:111], v[72:75], v[160:163], v[96:111]
    ds_read_b64_tr_b16 v[60:61], v24 offset:36864
    ds_read_b64_tr_b16 v[62:63], v24 offset:37376
    v_mfma_f32_32x32x16_bf16 v[112:127], v[160:163], v[76:79], v[112:127]
    ds_read_b64_tr_b16 v[64:65], v24 offset:45056
    ds_read_b64_tr_b16 v[66:67], v24 offset:45568
    s_waitcnt lgkmcnt(6)
    v_mfma_f32_32x32x16_bf16 v[80:95], v[44:47], v[164:167], v[80:95]
    ds_read_b64_tr_b16 v[68:69], v24 offset:30720
    ds_read_b64_tr_b16 v[70:71], v24 offset:31232
    v_mfma_f32_32x32x16_bf16 v[96:111], v[48:51], v[164:167], v[96:111]
    ds_read_b64_tr_b16 v[72:73], v24 offset:38912
    ds_read_b64_tr_b16 v[74:75], v24 offset:39424
    v_mfma_f32_32x32x16_bf16 v[112:127], v[164:167], v[52:55], v[112:127]
    ds_read_b64_tr_b16 v[76:77], v24 offset:47104
    ds_read_b64_tr_b16 v[78:79], v24 offset:47616
    s_waitcnt lgkmcnt(6)
    s_barrier
    v_mfma_f32_32x32x16_bf16 v[80:95], v[56:59], v[168:171], v[80:95]
    ds_read_b64_tr_b16 v[44:45], v26 offset:0
    ds_read_b64_tr_b16 v[46:47], v26 offset:512
    v_mfma_f32_32x32x16_bf16 v[96:111], v[60:63], v[168:171], v[96:111]
    ds_read_b64_tr_b16 v[48:49], v26 offset:8192
    ds_read_b64_tr_b16 v[50:51], v26 offset:8704
    v_mfma_f32_32x32x16_bf16 v[112:127], v[168:171], v[64:67], v[112:127]
    ds_read_b64_tr_b16 v[52:53], v26 offset:16384
    ds_read_b64_tr_b16 v[54:55], v26 offset:16896
    s_waitcnt lgkmcnt(6)
    v_mfma_f32_32x32x16_bf16 v[80:95], v[68:71], v[172:175], v[80:95]
    ds_read_b64_tr_b16 v[56:57], v26 offset:2048
    ds_read_b64_tr_b16 v[58:59], v26 offset:2560
    v_mfma_f32_32x32x16_bf16 v[96:111], v[72:75], v[172:175], v[96:111]
    ds_read_b64_tr_b16 v[60:61], v26 offset:10240
    ds_read_b64_tr_b16 v[62:63], v26 offset:10752
    v_mfma_f32_32x32x16_bf16 v[112:127], v[172:175], v[76:79], v[112:127]
    ds_read_b64_tr_b16 v[64:65], v26 offset:18432
    ds_read_b64_tr_b16 v[66:67], v26 offset:18944
    s_waitcnt lgkmcnt(6)
    v_mfma_f32_32x32x16_bf16 v[80:95], v[44:47], v[176:179], v[80:95]
    ds_read_b64_tr_b16 v[68:69], v26 offset:4096
    ds_read_b64_tr_b16 v[70:71], v26 offset:4608
    v_mfma_f32_32x32x16_bf16 v[96:111], v[48:51], v[176:179], v[96:111]
    ds_read_b64_tr_b16 v[72:73], v26 offset:12288
    ds_read_b64_tr_b16 v[74:75], v26 offset:12800
    v_mfma_f32_32x32x16_bf16 v[112:127], v[176:179], v[52:55], v[112:127]
    ds_read_b64_tr_b16 v[76:77], v26 offset:20480
    ds_read_b64_tr_b16 v[78:79], v26 offset:20992
    s_waitcnt lgkmcnt(6)
    v_mfma_f32_32x32x16_bf16 v[80:95], v[56:59], v[180:183], v[80:95]
    ds_read_b64_tr_b16 v[44:45], v26 offset:6144
    ds_read_b64_tr_b16 v[46:47], v26 offset:6656
    v_mfma_f32_32x32x16_bf16 v[96:111], v[60:63], v[180:183], v[96:111]
    ds_read_b64_tr_b16 v[48:49], v26 offset:14336
    ds_read_b64_tr_b16 v[50:51], v26 offset:14848
    v_mfma_f32_32x32x16_bf16 v[112:127], v[180:183], v[64:67], v[112:127]
    ds_read_b64_tr_b16 v[52:53], v26 offset:22528
    ds_read_b64_tr_b16 v[54:55], v26 offset:23040
    s_waitcnt lgkmcnt(6)
    s_barrier
    v_mfma_f32_32x32x16_bf16 v[80:95], v[68:71], v[184:187], v[80:95]
    ds_read_b64_tr_b16 v[56:57], v26 offset:24576
    ds_read_b64_tr_b16 v[58:59], v26 offset:25088
    v_mfma_f32_32x32x16_bf16 v[96:111], v[72:75], v[184:187], v[96:111]
    ds_read_b64_tr_b16 v[60:61], v26 offset:32768
    ds_read_b64_tr_b16 v[62:63], v26 offset:33280
    v_mfma_f32_32x32x16_bf16 v[112:127], v[184:187], v[76:79], v[112:127]
    ds_read_b64_tr_b16 v[64:65], v26 offset:40960
    ds_read_b64_tr_b16 v[66:67], v26 offset:41472
    s_waitcnt lgkmcnt(6)
    v_mfma_f32_32x32x16_bf16 v[80:95], v[44:47], v[188:191], v[80:95]
    ds_read_b64_tr_b16 v[68:69], v26 offset:26624
    ds_read_b64_tr_b16 v[70:71], v26 offset:27136
    v_mfma_f32_32x32x16_bf16 v[96:111], v[48:51], v[188:191], v[96:111]
    ds_read_b64_tr_b16 v[72:73], v26 offset:34816
    ds_read_b64_tr_b16 v[74:75], v26 offset:35328
    v_mfma_f32_32x32x16_bf16 v[112:127], v[188:191], v[52:55], v[112:127]
    ds_read_b64_tr_b16 v[76:77], v26 offset:43008
    ds_read_b64_tr_b16 v[78:79], v26 offset:43520
    s_waitcnt lgkmcnt(6)
    v_mfma_f32_32x32x16_bf16 v[80:95], v[56:59], v[192:195], v[80:95]
    ds_read_b64_tr_b16 v[44:45], v26 offset:28672
    ds_read_b64_tr_b16 v[46:47], v26 offset:29184
    v_mfma_f32_32x32x16_bf16 v[96:111], v[60:63], v[192:195], v[96:111]
    ds_read_b64_tr_b16 v[48:49], v26 offset:36864
    ds_read_b64_tr_b16 v[50:51], v26 offset:37376
    v_mfma_f32_32x32x16_bf16 v[112:127], v[192:195], v[64:67], v[112:127]
    ds_read_b64_tr_b16 v[52:53], v26 offset:45056
    ds_read_b64_tr_b16 v[54:55], v26 offset:45568
    s_waitcnt lgkmcnt(6)
    v_mfma_f32_32x32x16_bf16 v[80:95], v[68:71], v[196:199], v[80:95]
    ds_read_b64_tr_b16 v[56:57], v26 offset:30720
    ds_read_b64_tr_b16 v[58:59], v26 offset:31232
    v_mov_b32 v132, v30
    v_mov_b32 v133, v30
    v_mov_b32 v134, v30
    v_mfma_f32_32x32x16_bf16 v[96:111], v[72:75], v[196:199], v[96:111]
    ds_read_b64_tr_b16 v[60:61], v26 offset:38912
    ds_read_b64_tr_b16 v[62:63], v26 offset:39424
    v_mov_b32 v135, v30
    v_mov_b32 v136, v30
    v_mov_b32 v137, v30
    v_mfma_f32_32x32x16_bf16 v[112:127], v[196:199], v[76:79], v[112:127]
    ds_read_b64_tr_b16 v[64:65], v26 offset:47104
    ds_read_b64_tr_b16 v[66:67], v26 offset:47616
    v_mov_b32 v138, v30
    v_mov_b32 v139, v30
    s_waitcnt lgkmcnt(6)
    s_barrier
    v_mfma_f32_32x32x16_bf16 v[80:95], v[44:47], v[200:203], v[80:95]
    ds_read_b64_tr_b16 v[68:69], v25 offset:24576
    ds_read_b64_tr_b16 v[70:71], v25 offset:25088
    v_mov_b32 v144, v30
    v_mov_b32 v145, v30
    v_mov_b32 v146, v30
    v_mfma_f32_32x32x16_bf16 v[96:111], v[48:51], v[200:203], v[96:111]
    ds_read_b64_tr_b16 v[72:73], v25 offset:32768
    ds_read_b64_tr_b16 v[74:75], v25 offset:33280
    v_mov_b32 v147, v30
    v_mov_b32 v148, v30
    v_mov_b32 v149, v30
    v_mfma_f32_32x32x16_bf16 v[112:127], v[200:203], v[52:55], v[112:127]
    ds_read_b64_tr_b16 v[76:77], v25 offset:40960
    ds_read_b64_tr_b16 v[78:79], v25 offset:41472
    v_mov_b32 v150, v30
    v_mov_b32 v151, v30
    s_waitcnt lgkmcnt(6)
    buffer_load_dwordx2 v[18:19], v17, s[28:31], s48 offen sc1
    v_mfma_f32_32x32x16_bf16 v[80:95], v[56:59], v[204:207], v[80:95]
    ds_read_b64_tr_b16 v[44:45], v25 offset:26624
    ds_read_b64_tr_b16 v[46:47], v25 offset:27136
    v_mov_b32 v156, v30
    v_mov_b32 v157, v30
    v_mov_b32 v158, v30
    v_mfma_f32_32x32x16_bf16 v[96:111], v[60:63], v[204:207], v[96:111]
    ds_read_b64_tr_b16 v[48:49], v25 offset:34816
    ds_read_b64_tr_b16 v[50:51], v25 offset:35328
    v_mov_b32 v159, v30
    v_mov_b32 v160, v30
    v_mov_b32 v161, v30
    v_mfma_f32_32x32x16_bf16 v[112:127], v[204:207], v[64:67], v[112:127]
    ds_read_b64_tr_b16 v[52:53], v25 offset:43008
    ds_read_b64_tr_b16 v[54:55], v25 offset:43520
    v_mov_b32 v162, v30
    v_mov_b32 v163, v30
    s_waitcnt lgkmcnt(6)
    v_mfma_f32_32x32x16_bf16 v[80:95], v[68:71], v[208:211], v[80:95]
    ds_read_b64_tr_b16 v[56:57], v25 offset:28672
    ds_read_b64_tr_b16 v[58:59], v25 offset:29184
    v_mov_b32 v168, v30
    v_mov_b32 v169, v30
    v_mov_b32 v170, v30
    v_mfma_f32_32x32x16_bf16 v[96:111], v[72:75], v[208:211], v[96:111]
    ds_read_b64_tr_b16 v[60:61], v25 offset:36864
    ds_read_b64_tr_b16 v[62:63], v25 offset:37376
    v_mov_b32 v171, v30
    v_mov_b32 v172, v30
    v_mov_b32 v173, v30
    v_mfma_f32_32x32x16_bf16 v[112:127], v[208:211], v[76:79], v[112:127]
    ds_read_b64_tr_b16 v[64:65], v25 offset:45056
    ds_read_b64_tr_b16 v[66:67], v25 offset:45568
    v_mov_b32 v174, v30
    v_mov_b32 v175, v30
    s_waitcnt lgkmcnt(6)
    v_mfma_f32_32x32x16_bf16 v[80:95], v[44:47], v[212:215], v[80:95]
    ds_read_b64_tr_b16 v[68:69], v25 offset:30720
    ds_read_b64_tr_b16 v[70:71], v25 offset:31232
    v_mov_b32 v180, v30
    v_mov_b32 v181, v30
    v_mov_b32 v182, v30
    v_mfma_f32_32x32x16_bf16 v[96:111], v[48:51], v[212:215], v[96:111]
    ds_read_b64_tr_b16 v[72:73], v25 offset:38912
    ds_read_b64_tr_b16 v[74:75], v25 offset:39424
    v_mov_b32 v183, v30
    v_mov_b32 v184, v30
    v_mov_b32 v185, v30
    v_mfma_f32_32x32x16_bf16 v[112:127], v[212:215], v[52:55], v[112:127]
    ds_read_b64_tr_b16 v[76:77], v25 offset:47104
    ds_read_b64_tr_b16 v[78:79], v25 offset:47616
    v_mov_b32 v186, v30
    v_mov_b32 v187, v30
    s_waitcnt lgkmcnt(6)
    s_barrier
    v_mfma_f32_32x32x16_bf16 v[80:95], v[56:59], v[216:219], v[80:95]
    ds_read_b64_tr_b16 v[44:45], v24 offset:0
    ds_read_b64_tr_b16 v[46:47], v24 offset:512
    v_mov_b32 v192, v30
    v_mov_b32 v193, v30
    v_mov_b32 v194, v30
    v_mfma_f32_32x32x16_bf16 v[96:111], v[60:63], v[216:219], v[96:111]
    ds_read_b64_tr_b16 v[48:49], v24 offset:8192
    ds_read_b64_tr_b16 v[50:51], v24 offset:8704
    v_mov_b32 v195, v30
    v_mov_b32 v196, v30
    v_mov_b32 v197, v30
    v_mfma_f32_32x32x16_bf16 v[112:127], v[216:219], v[64:67], v[112:127]
    ds_read_b64_tr_b16 v[52:53], v24 offset:16384
    ds_read_b64_tr_b16 v[54:55], v24 offset:16896
    v_mov_b32 v198, v30
    v_mov_b32 v199, v30
    s_waitcnt lgkmcnt(6)
    v_mfma_f32_32x32x16_bf16 v[80:95], v[68:71], v[220:223], v[80:95]
    ds_read_b64_tr_b16 v[56:57], v24 offset:2048
    ds_read_b64_tr_b16 v[58:59], v24 offset:2560
    v_mov_b32 v204, v30
    v_mov_b32 v205, v30
    v_mov_b32 v206, v30
    v_mfma_f32_32x32x16_bf16 v[96:111], v[72:75], v[220:223], v[96:111]
    ds_read_b64_tr_b16 v[60:61], v24 offset:10240
    ds_read_b64_tr_b16 v[62:63], v24 offset:10752
    v_mov_b32 v207, v30
    v_mov_b32 v208, v30
    v_mov_b32 v209, v30
    v_mfma_f32_32x32x16_bf16 v[112:127], v[220:223], v[76:79], v[112:127]
    ds_read_b64_tr_b16 v[64:65], v24 offset:18432
    ds_read_b64_tr_b16 v[66:67], v24 offset:18944
    v_mov_b32 v210, v30
    v_mov_b32 v211, v30
    s_waitcnt lgkmcnt(6)
    v_mfma_f32_32x32x16_bf16 v[80:95], v[44:47], v[224:227], v[80:95]
    ds_read_b64_tr_b16 v[68:69], v24 offset:4096
    ds_read_b64_tr_b16 v[70:71], v24 offset:4608
    v_mov_b32 v216, v30
    v_mov_b32 v217, v30
    v_mov_b32 v218, v30
    v_mfma_f32_32x32x16_bf16 v[96:111], v[48:51], v[224:227], v[96:111]
    ds_read_b64_tr_b16 v[72:73], v24 offset:12288
    ds_read_b64_tr_b16 v[74:75], v24 offset:12800
    v_mov_b32 v219, v30
    v_mov_b32 v220, v30
    v_mov_b32 v221, v30
    v_mfma_f32_32x32x16_bf16 v[112:127], v[224:227], v[52:55], v[112:127]
    ds_read_b64_tr_b16 v[76:77], v24 offset:20480
    ds_read_b64_tr_b16 v[78:79], v24 offset:20992
    v_mov_b32 v222, v30
    v_mov_b32 v223, v30
    s_waitcnt lgkmcnt(6)
    v_mfma_f32_32x32x16_bf16 v[80:95], v[56:59], v[228:231], v[80:95]
    ds_read_b64_tr_b16 v[44:45], v24 offset:6144
    ds_read_b64_tr_b16 v[46:47], v24 offset:6656
    v_mfma_f32_32x32x16_bf16 v[96:111], v[60:63], v[228:231], v[96:111]
    ds_read_b64_tr_b16 v[48:49], v24 offset:14336
    ds_read_b64_tr_b16 v[50:51], v24 offset:14848
    v_mfma_f32_32x32x16_bf16 v[112:127], v[228:231], v[64:67], v[112:127]
    ds_read_b64_tr_b16 v[52:53], v24 offset:22528
    ds_read_b64_tr_b16 v[54:55], v24 offset:23040
    s_waitcnt lgkmcnt(6)
    v_mfma_f32_32x32x16_bf16 v[80:95], v[68:71], v[232:235], v[80:95]
    ds_read_b64_tr_b16 v[56:57], v24 offset:24576
    ds_read_b64_tr_b16 v[58:59], v24 offset:25088
    v_mfma_f32_32x32x16_bf16 v[96:111], v[72:75], v[232:235], v[96:111]
    ds_read_b64_tr_b16 v[60:61], v24 offset:32768
    ds_read_b64_tr_b16 v[62:63], v24 offset:33280
    v_mfma_f32_32x32x16_bf16 v[112:127], v[232:235], v[76:79], v[112:127]
    ds_read_b64_tr_b16 v[64:65], v24 offset:40960
    ds_read_b64_tr_b16 v[66:67], v24 offset:41472
    s_waitcnt lgkmcnt(6)
    v_mfma_f32_32x32x16_bf16 v[80:95], v[44:47], v[236:239], v[80:95]
    ds_read_b64_tr_b16 v[68:69], v24 offset:26624
    ds_read_b64_tr_b16 v[70:71], v24 offset:27136
    v_mfma_f32_32x32x16_bf16 v[96:111], v[48:51], v[236:239], v[96:111]
    ds_read_b64_tr_b16 v[72:73], v24 offset:34816
    ds_read_b64_tr_b16 v[74:75], v24 offset:35328
    v_mfma_f32_32x32x16_bf16 v[112:127], v[236:239], v[52:55], v[112:127]
    ds_read_b64_tr_b16 v[76:77], v24 offset:43008
    ds_read_b64_tr_b16 v[78:79], v24 offset:43520
    s_waitcnt vmcnt(0)
    v_cmp_ne_u64 vcc, s[76:77], v[18:19]
    s_cbranch_vccnz POLL7_S
POLLD7:
    s_mov_b32 s54, s52
    buffer_load_dwordx4 v[128:131], v6, s[28:31], s54 offen offset:0 sc1
    buffer_load_dwordx4 v[140:143], v6, s[28:31], s54 offen offset:2048 sc1
    s_mov_b64 exec, s[60:61]
    buffer_load_dwordx4 v[132:135], v3, s[28:31], s54 offen offset:1024 sc1
    buffer_load_dwordx4 v[136:139], v3, s[28:31], s54 offen offset:1536 sc1
    buffer_load_dwordx4 v[144:147], v3, s[28:31], s54 offen offset:3072 sc1
    buffer_load_dwordx4 v[148:151], v3, s[28:31], s54 offen offset:3584 sc1
    s_mov_b64 exec, -1
    s_add_u32 s54, s54, 4096
    s_waitcnt lgkmcnt(6)
    v_mfma_f32_32x32x16_bf16 v[80:95], v[56:59], v[240:243], v[80:95]
    ds_read_b64_tr_b16 v[44:45], v24 offset:28672
    ds_read_b64_tr_b16 v[46:47], v24 offset:29184
    v_mfma_f32_32x32x16_bf16 v[96:111], v[60:63], v[240:243], v[96:111]
    ds_read_b64_tr_b16 v[48:49], v24 offset:36864
    ds_read_b64_tr_b16 v[50:51], v24 offset:37376
    v_mfma_f32_32x32x16_bf16 v[112:127], v[240:243], v[64:67], v[112:127]
    ds_read_b64_tr_b16 v[52:53], v24 offset:45056
    ds_read_b64_tr_b16 v[54:55], v24 offset:45568
    s_waitcnt lgkmcnt(6)
    v_mfma_f32_32x32x16_bf16 v[80:95], v[68:71], v[244:247], v[80:95]
    ds_read_b64_tr_b16 v[56:57], v24 offset:30720
    ds_read_b64_tr_b16 v[58:59], v24 offset:31232
    v_mfma_f32_32x32x16_bf16 v[96:111], v[72:75], v[244:247], v[96:111]
    ds_read_b64_tr_b16 v[60:61], v24 offset:38912
    ds_read_b64_tr_b16 v[62:63], v24 offset:39424
    v_mfma_f32_32x32x16_bf16 v[112:127], v[244:247], v[76:79], v[112:127]
    ds_read_b64_tr_b16 v[64:65], v24 offset:47104
    ds_read_b64_tr_b16 v[66:67], v24 offset:47616
    s_waitcnt lgkmcnt(6)
    v_mfma_f32_32x32x16_bf16 v[80:95], v[44:47], v[248:251], v[80:95]
    v_mfma_f32_32x32x16_bf16 v[96:111], v[48:51], v[248:251], v[96:111]
    v_mfma_f32_32x32x16_bf16 v[112:127], v[248:251], v[52:55], v[112:127]
    s_waitcnt lgkmcnt(0)
    v_mfma_f32_32x32x16_bf16 v[80:95], v[56:59], v[252:255], v[80:95]
    v_mfma_f32_32x32x16_bf16 v[96:111], v[60:63], v[252:255], v[96:111]
    v_mfma_f32_32x32x16_bf16 v[112:127], v[252:255], v[64:67], v[112:127]
    s_mov_b64 exec, 1
    ds_add_u32 v42, v43 offset:0
    s_mov_b64 exec, -1
    s_setprio 3
    s_nop 7
    v_cvt_pk_bf16_f32 v240, v96, v97
    v_cvt_pk_bf16_f32 v241, v98, v99
    v_cvt_pk_bf16_f32 v242, v100, v101
    v_cvt_pk_bf16_f32 v243, v102, v103
    v_cvt_pk_bf16_f32 v244, v104, v105
    v_cvt_pk_bf16_f32 v245, v106, v107
    v_cvt_pk_bf16_f32 v246, v108, v109
    v_cvt_pk_bf16_f32 v247, v110, v111
    v_cvt_pk_bf16_f32 v252, v120, v121
    v_cvt_pk_bf16_f32 v253, v122, v123
    v_cvt_pk_bf16_f32 v254, v124, v125
    v_cvt_pk_bf16_f32 v255, v126, v127
    v_cvt_pk_bf16_f32 v248, v112, v113
    v_cvt_pk_bf16_f32 v249, v114, v115
    v_cvt_pk_bf16_f32 v250, v116, v117
    v_cvt_pk_bf16_f32 v251, v118, v119
    v_mul_f32 v80, s85, v80
    v_mul_f32 v81, s85, v81
    v_mul_f32 v82, s85, v82
    v_mul_f32 v83, s85, v83
    v_mul_f32 v84, s85, v84
    v_mul_f32 v85, s85, v85
    v_mul_f32 v86, s85, v86
    v_mul_f32 v87, s85, v87
    v_cvt_pk_bf16_f32 v232, v80, v81
    v_cvt_pk_bf16_f32 v233, v82, v83
    v_cvt_pk_bf16_f32 v234, v84, v85
    v_cvt_pk_bf16_f32 v235, v86, v87
    v_mul_f32 v88, s85, v88
    v_mul_f32 v89, s85, v89
    v_mul_f32 v90, s85, v90
    v_mul_f32 v91, s85, v91
    v_mul_f32 v92, s85, v92
    v_mul_f32 v93, s85, v93
    v_mul_f32 v94, s85, v94
    v_mul_f32 v95, s85, v95
    v_cvt_pk_bf16_f32 v236, v88, v89
    v_cvt_pk_bf16_f32 v237, v90, v91
    v_cvt_pk_bf16_f32 v238, v92, v93
    v_cvt_pk_bf16_f32 v239, v94, v95
    v_cmp_gt_u32 vcc, 32, v1
    v_mov_b32 v92, 0x3f80
    v_mov_b32 v227, v30
    v_cndmask_b32 v80, 0, v92, vcc
    v_mov_b32 v81, 0
    v_mov_b32 v82, 0
    v_mov_b32 v83, 0
    v_mov_b32 v85, 0
    v_mov_b32 v86, 0
    v_mov_b32 v87, 0
    v_mov_b32 v89, 0
    v_mov_b32 v90, 0
    v_mov_b32 v91, 0
    v_lshlrev_b32 v225, 3, v5
    v_lshrrev_b32 v226, 3, v1
    v_lshlrev_b32 v226, 10, v226
    v_bfe_u32 v92, v1, 4, 1
    v_lshlrev_b32 v92, 2, v92
    v_and_b32 v93, 7, v1
    v_xor_b32 v92, v92, v93
    v_lshl_add_u32 v226, v92, 4, v226
    v_mov_b32 v224, 65536
    s_sub_u32 s88, s3, 128
    s_cmp_eq_u32 s10, 0
    s_cselect_b32 s88, s3, s88
    s_mov_b32 s24, s38
    s_mov_b32 s25, s39
    s_mov_b32 s26, 0x10000000
    s_mov_b32 s27, 0x20000
    s_waitcnt vmcnt(5)
    v_mfma_f32_32x32x16_bf16 v[48:63], v[128:131], v[8:11], 0
    v_mfma_f32_32x32x16_bf16 v[64:79], v[128:131], v[12:15], 0
    buffer_load_dwordx4 v[152:155], v6, s[28:31], s54 offen offset:0 sc1
    buffer_load_dwordx4 v[164:167], v6, s[28:31], s54 offen offset:2048 sc1
    s_mov_b64 exec, s[60:61]
    buffer_load_dwordx4 v[156:159], v3, s[28:31], s54 offen offset:1024 sc1
    buffer_load_dwordx4 v[160:163], v3, s[28:31], s54 offen offset:1536 sc1
    buffer_load_dwordx4 v[168:171], v3, s[28:31], s54 offen offset:3072 sc1
    buffer_load_dwordx4 v[172:175], v3, s[28:31], s54 offen offset:3584 sc1
    s_mov_b64 exec, -1
    s_add_u32 s54, s54, 4096
    buffer_load_dwordx4 v[176:179], v6, s[28:31], s54 offen offset:0 sc1
    buffer_load_dwordx4 v[188:191], v6, s[28:31], s54 offen offset:2048 sc1
    s_mov_b64 exec, s[60:61]
    buffer_load_dwordx4 v[180:183], v3, s[28:31], s54 offen offset:1024 sc1
    buffer_load_dwordx4 v[184:187], v3, s[28:31], s54 offen offset:1536 sc1
    buffer_load_dwordx4 v[192:195], v3, s[28:31], s54 offen offset:3072 sc1
    buffer_load_dwordx4 v[196:199], v3, s[28:31], s54 offen offset:3584 sc1
    s_mov_b64 exec, -1
    s_add_u32 s54, s54, 4096
    v_max3_f32 v92, v48, v49, v50
    v_max3_f32 v92, v92, v51, v52
    v_max3_f32 v92, v92, v53, v54
    v_max3_f32 v92, v92, v55, v56
    v_max3_f32 v92, v92, v57, v58
    v_max3_f32 v92, v92, v59, v60
    v_max3_f32 v92, v92, v61, v62
    v_max_f32 v92, v92, v63
    v_add_f32 v92, 0x42200000, v92
    v_cvt_pk_bf16_f32 v84, -v92, 0
    s_nop 1
    v_mfma_f32_32x32x16_bf16 v[16:31], v[80:83], v[84:87], 0
    v_max3_f32 v93, v64, v65, v66
    v_max3_f32 v93, v93, v67, v68
    v_max3_f32 v93, v93, v69, v70
    v_max3_f32 v93, v93, v71, v72
    v_max3_f32 v93, v93, v73, v74
    v_max3_f32 v93, v93, v75, v76
    v_max3_f32 v93, v93, v77, v78
    v_max_f32 v93, v93, v79
    v_add_f32 v93, 0x42200000, v93
    v_cvt_pk_bf16_f32 v88, -v93, 0
    s_nop 1
    v_mfma_f32_32x32x16_bf16 v[32:47], v[80:83], v[88:91], 0
A_MAIN_G:
    v_mov_b32 v48, 0
    v_mov_b32 v49, 0
    v_mov_b32 v50, 0
    v_mov_b32 v51, 0
    v_mov_b32 v52, 0
    v_mov_b32 v53, 0
    v_mov_b32 v54, 0
    v_mov_b32 v55, 0
    v_mov_b32 v56, 0
    v_mov_b32 v57, 0
    v_mov_b32 v58, 0
    v_mov_b32 v59, 0
    v_mov_b32 v60, 0
    v_mov_b32 v61, 0
    v_mov_b32 v62, 0
    v_mov_b32 v63, 0
    v_mov_b32 v64, 0
    v_mov_b32 v65, 0
    v_mov_b32 v66, 0
    v_mov_b32 v67, 0
    v_mov_b32 v68, 0
    v_mov_b32 v69, 0
    v_mov_b32 v70, 0
    v_mov_b32 v71, 0
    v_mov_b32 v72, 0
    v_mov_b32 v73, 0
    v_mov_b32 v74, 0
    v_mov_b32 v75, 0
    v_mov_b32 v76, 0
    v_mov_b32 v77, 0
    v_mov_b32 v78, 0
    v_mov_b32 v79, 0
    v_mfma_f32_32x32x16_bf16 v[80:95], v[128:131], v[8:11], v[16:31]
    v_mfma_f32_32x32x16_bf16 v[96:111], v[128:131], v[12:15], v[32:47]
    s_nop 10
    v_exp_f32 v80, v80
    v_exp_f32 v81, v81
    v_exp_f32 v82, v82
    v_exp_f32 v83, v83
    v_exp_f32 v84, v84
    v_exp_f32 v85, v85
    buffer_load_dwordx4 v[200:203], v6, s[28:31], s54 offen offset:0 sc1
    buffer_load_dwordx4 v[212:215], v6, s[28:31], s54 offen offset:2048 sc1
    s_mov_b64 exec, s[60:61]
    buffer_load_dwordx4 v[204:207], v3, s[28:31], s54 offen offset:1024 sc1
    buffer_load_dwordx4 v[208:211], v3, s[28:31], s54 offen offset:1536 sc1
    buffer_load_dwordx4 v[216:219], v3, s[28:31], s54 offen offset:3072 sc1
    buffer_load_dwordx4 v[220:223], v3, s[28:31], s54 offen offset:3584 sc1
    s_mov_b64 exec, -1
    s_add_u32 s54, s54, 4096
    s_setprio 3
    v_exp_f32 v86, v86
    v_exp_f32 v87, v87
    s_waitcnt vmcnt(22)
    v_mfma_f32_32x32x16_bf16 v[112:127], v[140:143], v[8:11], v[16:31]
    v_exp_f32 v88, v88
    v_exp_f32 v89, v89
    v_exp_f32 v90, v90
    v_exp_f32 v91, v91
    v_exp_f32 v92, v92
    s_waitcnt vmcnt(20)
    v_smfmac_f32_32x32x32_bf16 v[48:63], v[132:135], v[80:87], v7
    v_exp_f32 v93, v93
    v_exp_f32 v94, v94
    v_exp_f32 v95, v95
    v_exp_f32 v96, v96
    v_exp_f32 v97, v97
    v_exp_f32 v98, v98
    v_smfmac_f32_32x32x32_bf16 v[48:63], v[136:139], v[88:95], v7
    v_exp_f32 v99, v99
    v_exp_f32 v100, v100
    v_exp_f32 v101, v101
    ds_read_b32 v228, v224
    v_exp_f32 v102, v102
    v_exp_f32 v103, v103
    v_mfma_f32_32x32x16_bf16 v[80:95], v[140:143], v[12:15], v[32:47]
    v_exp_f32 v104, v104
    v_exp_f32 v105, v105
    v_exp_f32 v106, v106
    v_exp_f32 v107, v107
    v_exp_f32 v108, v108
    v_smfmac_f32_32x32x32_bf16 v[64:79], v[132:135], v[96:103], v7
    v_exp_f32 v109, v109
    v_exp_f32 v110, v110
    v_exp_f32 v111, v111
    v_exp_f32 v112, v112
    v_exp_f32 v113, v113
    v_exp_f32 v114, v114
    v_smfmac_f32_32x32x32_bf16 v[64:79], v[136:139], v[104:111], v7
    v_exp_f32 v115, v115
    v_exp_f32 v116, v116
    v_exp_f32 v117, v117
    s_setprio 2
    v_exp_f32 v118, v118
    v_exp_f32 v119, v119
    s_waitcnt vmcnt(17)
    v_mfma_f32_32x32x16_bf16 v[96:111], v[152:155], v[8:11], v[16:31]
    v_exp_f32 v120, v120
    v_exp_f32 v121, v121
    v_exp_f32 v122, v122
    v_exp_f32 v123, v123
    v_exp_f32 v124, v124
    v_smfmac_f32_32x32x32_bf16 v[48:63], v[144:147], v[112:119], v7
    v_exp_f32 v125, v125
    v_exp_f32 v126, v126
    v_exp_f32 v127, v127
    v_exp_f32 v80, v80
    v_exp_f32 v81, v81
    v_exp_f32 v82, v82
    v_smfmac_f32_32x32x32_bf16 v[48:63], v[148:151], v[120:127], v7
    v_exp_f32 v83, v83
    v_exp_f32 v84, v84
    v_exp_f32 v85, v85
    s_waitcnt lgkmcnt(0)
    v_cmp_gt_u32 vcc, 4, v228
    s_cbranch_vccnz LC8_S
LCD8:
    v_exp_f32 v86, v86
    v_exp_f32 v87, v87
    v_mfma_f32_32x32x16_bf16 v[112:127], v[152:155], v[12:15], v[32:47]
    v_exp_f32 v88, v88
    v_exp_f32 v89, v89
    v_exp_f32 v90, v90
    v_exp_f32 v91, v91
    v_exp_f32 v92, v92
    v_smfmac_f32_32x32x32_bf16 v[64:79], v[144:147], v[80:87], v7
    v_exp_f32 v93, v93
    v_exp_f32 v94, v94
    v_exp_f32 v95, v95
    v_exp_f32 v96, v96
    v_exp_f32 v97, v97
    v_exp_f32 v98, v98
    v_smfmac_f32_32x32x32_bf16 v[64:79], v[148:151], v[88:95], v7
    v_exp_f32 v99, v99
    v_exp_f32 v100, v100
    v_exp_f32 v101, v101
    buffer_load_dwordx4 v[128:131], v6, s[28:31], s54 offen offset:0 sc1
    buffer_load_dwordx4 v[140:143], v6, s[28:31], s54 offen offset:2048 sc1
    s_mov_b64 exec, s[60:61]
    buffer_load_dwordx4 v[132:135], v3, s[28:31], s54 offen offset:1024 sc1
    buffer_load_dwordx4 v[136:139], v3, s[28:31], s54 offen offset:1536 sc1
    buffer_load_dwordx4 v[144:147], v3, s[28:31], s54 offen offset:3072 sc1
    buffer_load_dwordx4 v[148:151], v3, s[28:31], s54 offen offset:3584 sc1
    s_mov_b64 exec, -1
    s_add_u32 s54, s54, 4096
    s_setprio 1
    v_exp_f32 v102, v102
    v_exp_f32 v103, v103
    s_waitcnt vmcnt(22)
    v_mfma_f32_32x32x16_bf16 v[80:95], v[164:167], v[8:11], v[16:31]
    v_exp_f32 v104, v104
    v_exp_f32 v105, v105
    v_exp_f32 v106, v106
    v_exp_f32 v107, v107
    v_exp_f32 v108, v108
    s_waitcnt vmcnt(20)
    v_smfmac_f32_32x32x32_bf16 v[48:63], v[156:159], v[96:103], v7
    v_exp_f32 v109, v109
    v_exp_f32 v110, v110
    v_exp_f32 v111, v111
    v_exp_f32 v112, v112
    v_exp_f32 v113, v113
    v_exp_f32 v114, v114
    v_smfmac_f32_32x32x32_bf16 v[48:63], v[160:163], v[104:111], v7
    v_exp_f32 v115, v115
    v_exp_f32 v116, v116
    v_exp_f32 v117, v117
    s_add_u32 m0, s58, s56
    s_lshl_b32 s57, s56, 3
    s_add_u32 s57, s57, s59
    buffer_load_dwordx4 v226, s[20:23], s57 offen lds
    s_add_u32 s56, s56, 1024
    v_exp_f32 v118, v118
    v_exp_f32 v119, v119
    v_mfma_f32_32x32x16_bf16 v[96:111], v[164:167], v[12:15], v[32:47]
    v_exp_f32 v120, v120
    v_exp_f32 v121, v121
    v_exp_f32 v122, v122
    v_exp_f32 v123, v123
    v_exp_f32 v124, v124
    v_smfmac_f32_32x32x32_bf16 v[64:79], v[156:159], v[112:119], v7
    v_exp_f32 v125, v125
    v_exp_f32 v126, v126
    v_exp_f32 v127, v127
    v_exp_f32 v80, v80
    v_exp_f32 v81, v81
    v_exp_f32 v82, v82
    v_smfmac_f32_32x32x32_bf16 v[64:79], v[160:163], v[120:127], v7
    v_exp_f32 v83, v83
    v_exp_f32 v84, v84
    v_exp_f32 v85, v85
    buffer_store_dwordx4 v[240:243], v2, s[28:31], s87 offen offset:0 sc1
    s_setprio 0
    v_exp_f32 v86, v86
    v_exp_f32 v87, v87
    s_waitcnt vmcnt(19)
    v_mfma_f32_32x32x16_bf16 v[112:127], v[176:179], v[8:11], v[16:31]
    v_exp_f32 v88, v88
    v_exp_f32 v89, v89
    v_exp_f32 v90, v90
    v_exp_f32 v91, v91
    v_exp_f32 v92, v92
    v_smfmac_f32_32x32x32_bf16 v[48:63], v[168:171], v[80:87], v7
    v_exp_f32 v93, v93
    v_exp_f32 v94, v94
    v_exp_f32 v95, v95
    v_exp_f32 v96, v96
    v_exp_f32 v97, v97
    v_exp_f32 v98, v98
    v_smfmac_f32_32x32x32_bf16 v[48:63], v[172:175], v[88:95], v7
    v_exp_f32 v99, v99
    v_exp_f32 v100, v100
    v_exp_f32 v101, v101
    s_add_u32 m0, s58, s56
    s_lshl_b32 s57, s56, 3
    s_add_u32 s57, s57, s59
    buffer_load_dwordx4 v226, s[20:23], s57 offen lds
    s_add_u32 s56, s56, 1024
    v_exp_f32 v102, v102
    v_exp_f32 v103, v103
    v_mfma_f32_32x32x16_bf16 v[80:95], v[176:179], v[12:15], v[32:47]
    v_exp_f32 v104, v104
    v_exp_f32 v105, v105
    v_exp_f32 v106, v106
    v_exp_f32 v107, v107
    v_exp_f32 v108, v108
    v_smfmac_f32_32x32x32_bf16 v[64:79], v[168:171], v[96:103], v7
    v_exp_f32 v109, v109
    v_exp_f32 v110, v110
    v_exp_f32 v111, v111
    v_exp_f32 v112, v112
    v_exp_f32 v113, v113
    v_exp_f32 v114, v114
    v_smfmac_f32_32x32x32_bf16 v[64:79], v[172:175], v[104:111], v7
    v_exp_f32 v115, v115
    v_exp_f32 v116, v116
    v_exp_f32 v117, v117
    buffer_load_dwordx4 v[152:155], v6, s[28:31], s54 offen offset:0 sc1
    buffer_load_dwordx4 v[164:167], v6, s[28:31], s54 offen offset:2048 sc1
    s_mov_b64 exec, s[60:61]
    buffer_load_dwordx4 v[156:159], v3, s[28:31], s54 offen offset:1024 sc1
    buffer_load_dwordx4 v[160:163], v3, s[28:31], s54 offen offset:1536 sc1
    buffer_load_dwordx4 v[168:171], v3, s[28:31], s54 offen offset:3072 sc1
    buffer_load_dwordx4 v[172:175], v3, s[28:31], s54 offen offset:3584 sc1
    s_mov_b64 exec, -1
    s_add_u32 s54, s54, 4096
    s_setprio 3
    v_exp_f32 v118, v118
    v_exp_f32 v119, v119
    s_waitcnt vmcnt(25)
    v_mfma_f32_32x32x16_bf16 v[96:111], v[188:191], v[8:11], v[16:31]
    v_exp_f32 v120, v120
    v_exp_f32 v121, v121
    v_exp_f32 v122, v122
    v_exp_f32 v123, v123
    v_exp_f32 v124, v124
    s_waitcnt vmcnt(23)
    v_smfmac_f32_32x32x32_bf16 v[48:63], v[180:183], v[112:119], v7
    v_exp_f32 v125, v125
    v_exp_f32 v126, v126
    v_exp_f32 v127, v127
    v_exp_f32 v80, v80
    v_exp_f32 v81, v81
    v_exp_f32 v82, v82
    v_smfmac_f32_32x32x32_bf16 v[48:63], v[184:187], v[120:127], v7
    v_exp_f32 v83, v83
    v_exp_f32 v84, v84
    v_exp_f32 v85, v85
    s_add_u32 m0, s58, s56
    s_lshl_b32 s57, s56, 3
    s_add_u32 s57, s57, s59
    buffer_load_dwordx4 v226, s[20:23], s57 offen lds
    s_add_u32 s56, s56, 1024
    v_exp_f32 v86, v86
    v_exp_f32 v87, v87
    v_mfma_f32_32x32x16_bf16 v[112:127], v[188:191], v[12:15], v[32:47]
    v_exp_f32 v88, v88
    v_exp_f32 v89, v89
    v_exp_f32 v90, v90
    v_exp_f32 v91, v91
    v_exp_f32 v92, v92
    v_smfmac_f32_32x32x32_bf16 v[64:79], v[180:183], v[80:87], v7
    v_exp_f32 v93, v93
    v_exp_f32 v94, v94
    v_exp_f32 v95, v95
    v_exp_f32 v96, v96
    v_exp_f32 v97, v97
    v_exp_f32 v98, v98
    v_smfmac_f32_32x32x32_bf16 v[64:79], v[184:187], v[88:95], v7
    v_exp_f32 v99, v99
    v_exp_f32 v100, v100
    v_exp_f32 v101, v101
    buffer_store_dwordx4 v[244:247], v2, s[28:31], s87 offen offset:1024 sc1
    s_setprio 2
    v_exp_f32 v102, v102
    v_exp_f32 v103, v103
    s_waitcnt vmcnt(22)
    v_mfma_f32_32x32x16_bf16 v[80:95], v[200:203], v[8:11], v[16:31]
    v_exp_f32 v104, v104
    v_exp_f32 v105, v105
    v_exp_f32 v106, v106
    v_exp_f32 v107, v107
    v_exp_f32 v108, v108
    v_smfmac_f32_32x32x32_bf16 v[48:63], v[192:195], v[96:103], v7
    v_exp_f32 v109, v109
    v_exp_f32 v110, v110
    v_exp_f32 v111, v111
    v_exp_f32 v112, v112
    v_exp_f32 v113, v113
    v_exp_f32 v114, v114
    v_smfmac_f32_32x32x32_bf16 v[48:63], v[196:199], v[104:111], v7
    v_exp_f32 v115, v115
    v_exp_f32 v116, v116
    v_exp_f32 v117, v117
    v_exp_f32 v118, v118
    v_exp_f32 v119, v119
    v_mfma_f32_32x32x16_bf16 v[96:111], v[200:203], v[12:15], v[32:47]
    v_exp_f32 v120, v120
    v_exp_f32 v121, v121
    v_exp_f32 v122, v122
    v_exp_f32 v123, v123
    v_exp_f32 v124, v124
    v_smfmac_f32_32x32x32_bf16 v[64:79], v[192:195], v[112:119], v7
    v_exp_f32 v125, v125
    v_exp_f32 v126, v126
    v_exp_f32 v127, v127
    v_exp_f32 v80, v80
    v_exp_f32 v81, v81
    v_exp_f32 v82, v82
    v_smfmac_f32_32x32x32_bf16 v[64:79], v[196:199], v[120:127], v7
    v_exp_f32 v83, v83
    v_exp_f32 v84, v84
    v_exp_f32 v85, v85
    buffer_load_dwordx4 v[176:179], v6, s[28:31], s54 offen offset:0 sc1
    buffer_load_dwordx4 v[188:191], v6, s[28:31], s54 offen offset:2048 sc1
    s_mov_b64 exec, s[60:61]
    buffer_load_dwordx4 v[180:183], v3, s[28:31], s54 offen offset:1024 sc1
    buffer_load_dwordx4 v[184:187], v3, s[28:31], s54 offen offset:1536 sc1
    buffer_load_dwordx4 v[192:195], v3, s[28:31], s54 offen offset:3072 sc1
    buffer_load_dwordx4 v[196:199], v3, s[28:31], s54 offen offset:3584 sc1
    s_mov_b64 exec, -1
    s_add_u32 s54, s54, 4096
    s_setprio 1
    v_exp_f32 v86, v86
    v_exp_f32 v87, v87
    s_waitcnt vmcnt(27)
    v_mfma_f32_32x32x16_bf16 v[112:127], v[212:215], v[8:11], v[16:31]
    v_exp_f32 v88, v88
    v_exp_f32 v89, v89
    v_exp_f32 v90, v90
    v_exp_f32 v91, v91
    v_exp_f32 v92, v92
    s_waitcnt vmcnt(25)
    v_smfmac_f32_32x32x32_bf16 v[48:63], v[204:207], v[80:87], v7
    v_exp_f32 v93, v93
    v_exp_f32 v94, v94
    v_exp_f32 v95, v95
    v_exp_f32 v96, v96
    v_exp_f32 v97, v97
    v_exp_f32 v98, v98
    v_smfmac_f32_32x32x32_bf16 v[48:63], v[208:211], v[88:95], v7
    v_exp_f32 v99, v99
    v_exp_f32 v100, v100
    v_exp_f32 v101, v101
    s_add_u32 m0, s58, s56
    s_lshl_b32 s57, s56, 3
    s_add_u32 s57, s57, s59
    buffer_load_dwordx4 v226, s[20:23], s57 offen lds
    s_add_u32 s56, s56, 1024
    v_exp_f32 v102, v102
    v_exp_f32 v103, v103
    v_mfma_f32_32x32x16_bf16 v[80:95], v[212:215], v[12:15], v[32:47]
    v_exp_f32 v104, v104
    v_exp_f32 v105, v105
    v_exp_f32 v106, v106
    v_exp_f32 v107, v107
    v_exp_f32 v108, v108
    v_smfmac_f32_32x32x32_bf16 v[64:79], v[204:207], v[96:103], v7
    v_exp_f32 v109, v109
    v_exp_f32 v110, v110
    v_exp_f32 v111, v111
    v_exp_f32 v112, v112
    v_exp_f32 v113, v113
    v_exp_f32 v114, v114
    v_smfmac_f32_32x32x32_bf16 v[64:79], v[208:211], v[104:111], v7
    v_exp_f32 v115, v115
    v_exp_f32 v116, v116
    v_exp_f32 v117, v117
    buffer_store_dwordx4 v[252:255], v2, s[28:31], s87 offen offset:2048 sc1
    s_setprio 0
    v_exp_f32 v118, v118
    v_exp_f32 v119, v119
    s_waitcnt vmcnt(24)
    v_mfma_f32_32x32x16_bf16 v[96:111], v[128:131], v[8:11], v[16:31]
    v_exp_f32 v120, v120
    v_exp_f32 v121, v121
    v_exp_f32 v122, v122
    v_exp_f32 v123, v123
    v_exp_f32 v124, v124
    v_smfmac_f32_32x32x32_bf16 v[48:63], v[216:219], v[112:119], v7
    v_exp_f32 v125, v125
    v_exp_f32 v126, v126
    v_exp_f32 v127, v127
    v_exp_f32 v80, v80
    v_exp_f32 v81, v81
    v_exp_f32 v82, v82
    v_smfmac_f32_32x32x32_bf16 v[48:63], v[220:223], v[120:127], v7
    v_exp_f32 v83, v83
    v_exp_f32 v84, v84
    v_exp_f32 v85, v85
    s_add_u32 m0, s58, s56
    s_lshl_b32 s57, s56, 3
    s_add_u32 s57, s57, s59
    buffer_load_dwordx4 v226, s[20:23], s57 offen lds
    s_add_u32 s56, s56, 1024
    v_exp_f32 v86, v86
    v_exp_f32 v87, v87
    v_mfma_f32_32x32x16_bf16 v[112:127], v[128:131], v[12:15], v[32:47]
    v_exp_f32 v88, v88
    v_exp_f32 v89, v89
    v_exp_f32 v90, v90
    v_exp_f32 v91, v91
    v_exp_f32 v92, v92
    v_smfmac_f32_32x32x32_bf16 v[64:79], v[216:219], v[80:87], v7
    v_exp_f32 v93, v93
    v_exp_f32 v94, v94
    v_exp_f32 v95, v95
    v_exp_f32 v96, v96
    v_exp_f32 v97, v97
    v_exp_f32 v98, v98
    v_smfmac_f32_32x32x32_bf16 v[64:79], v[220:223], v[88:95], v7
    v_exp_f32 v99, v99
    v_exp_f32 v100, v100
    v_exp_f32 v101, v101
    buffer_load_dwordx4 v[200:203], v6, s[28:31], s54 offen offset:0 sc1
    buffer_load_dwordx4 v[212:215], v6, s[28:31], s54 offen offset:2048 sc1
    s_mov_b64 exec, s[60:61]
    buffer_load_dwordx4 v[204:207], v3, s[28:31], s54 offen offset:1024 sc1
    buffer_load_dwordx4 v[208:211], v3, s[28:31], s54 offen offset:1536 sc1
    buffer_load_dwordx4 v[216:219], v3, s[28:31], s54 offen offset:3072 sc1
    buffer_load_dwordx4 v[220:223], v3, s[28:31], s54 offen offset:3584 sc1
    s_mov_b64 exec, -1
    s_add_u32 s54, s54, 4096
    s_setprio 3
    v_exp_f32 v102, v102
    v_exp_f32 v103, v103
    s_waitcnt vmcnt(30)
    v_mfma_f32_32x32x16_bf16 v[80:95], v[140:143], v[8:11], v[16:31]
    v_exp_f32 v104, v104
    v_exp_f32 v105, v105
    v_exp_f32 v106, v106
    v_exp_f32 v107, v107
    v_exp_f32 v108, v108
    s_waitcnt vmcnt(28)
    v_smfmac_f32_32x32x32_bf16 v[48:63], v[132:135], v[96:103], v7
    v_exp_f32 v109, v109
    v_exp_f32 v110, v110
    v_exp_f32 v111, v111
    v_exp_f32 v112, v112
    v_exp_f32 v113, v113
    v_exp_f32 v114, v114
    v_smfmac_f32_32x32x32_bf16 v[48:63], v[136:139], v[104:111], v7
    v_exp_f32 v115, v115
    v_exp_f32 v116, v116
    v_exp_f32 v117, v117
    v_exp_f32 v118, v118
    v_exp_f32 v119, v119
    v_mfma_f32_32x32x16_bf16 v[96:111], v[140:143], v[12:15], v[32:47]
    v_exp_f32 v120, v120
    v_exp_f32 v121, v121
    v_exp_f32 v122, v122
    v_exp_f32 v123, v123
    v_exp_f32 v124, v124
    v_smfmac_f32_32x32x32_bf16 v[64:79], v[132:135], v[112:119], v7
    v_exp_f32 v125, v125
    v_exp_f32 v126, v126
    v_exp_f32 v127, v127
    v_exp_f32 v80, v80
    v_exp_f32 v81, v81
    v_exp_f32 v82, v82
    v_smfmac_f32_32x32x32_bf16 v[64:79], v[136:139], v[120:127], v7
    v_exp_f32 v83, v83
    v_exp_f32 v84, v84
    v_exp_f32 v85, v85
    s_lshl_b32 s89, s10, 6
    s_lshl_b32 s47, s11, 1
    s_add_u32 s89, s89, s47
    s_lshl_b32 s89, s89, 10
    s_add_u32 s89, s89, 0xc00000
    v_mov_b32 v228, -1
    v_mov_b32 v229, -1
    v_mov_b32 v230, -1
    v_mov_b32 v231, -1
    buffer_store_dwordx4 v[228:231], v2, s[24:27], s89 offen sc1
    s_setprio 2
    v_exp_f32 v86, v86
    v_exp_f32 v87, v87
    s_waitcnt vmcnt(23)
    v_mfma_f32_32x32x16_bf16 v[112:127], v[152:155], v[8:11], v[16:31]
    v_exp_f32 v88, v88
    v_exp_f32 v89, v89
    v_exp_f32 v90, v90
    v_exp_f32 v91, v91
    v_exp_f32 v92, v92
    v_smfmac_f32_32x32x32_bf16 v[48:63], v[144:147], v[80:87], v7
    v_exp_f32 v93, v93
    v_exp_f32 v94, v94
    v_exp_f32 v95, v95
    v_exp_f32 v96, v96
    v_exp_f32 v97, v97
    v_exp_f32 v98, v98
    v_smfmac_f32_32x32x32_bf16 v[48:63], v[148:151], v[88:95], v7
    v_exp_f32 v99, v99
    v_exp_f32 v100, v100
    v_exp_f32 v101, v101
    s_add_u32 m0, s58, s56
    s_lshl_b32 s57, s56, 3
    s_add_u32 s57, s57, s59
    buffer_load_dwordx4 v226, s[20:23], s57 offen lds
    s_add_u32 s56, s56, 1024
    v_exp_f32 v102, v102
    v_exp_f32 v103, v103
    v_mfma_f32_32x32x16_bf16 v[80:95], v[152:155], v[12:15], v[32:47]
    v_exp_f32 v104, v104
    v_exp_f32 v105, v105
    v_exp_f32 v106, v106
    v_exp_f32 v107, v107
    v_exp_f32 v108, v108
    v_smfmac_f32_32x32x32_bf16 v[64:79], v[144:147], v[96:103], v7
    v_exp_f32 v109, v109
    v_exp_f32 v110, v110
    v_exp_f32 v111, v111
    v_exp_f32 v112, v112
    v_exp_f32 v113, v113
    v_exp_f32 v114, v114
    v_smfmac_f32_32x32x32_bf16 v[64:79], v[148:151], v[104:111], v7
    v_exp_f32 v115, v115
    v_exp_f32 v116, v116
    v_exp_f32 v117, v117
    buffer_load_dwordx4 v[128:131], v6, s[28:31], s54 offen offset:0 sc1
    buffer_load_dwordx4 v[140:143], v6, s[28:31], s54 offen offset:2048 sc1
    s_mov_b64 exec, s[60:61]
    buffer_load_dwordx4 v[132:135], v3, s[28:31], s54 offen offset:1024 sc1
    buffer_load_dwordx4 v[136:139], v3, s[28:31], s54 offen offset:1536 sc1
    buffer_load_dwordx4 v[144:147], v3, s[28:31], s54 offen offset:3072 sc1
    buffer_load_dwordx4 v[148:151], v3, s[28:31], s54 offen offset:3584 sc1
    s_mov_b64 exec, -1
    s_add_u32 s54, s54, 4096
    s_setprio 1
    v_exp_f32 v118, v118
    v_exp_f32 v119, v119
    s_waitcnt vmcnt(29)
    v_mfma_f32_32x32x16_bf16 v[96:111], v[164:167], v[8:11], v[16:31]
    v_exp_f32 v120, v120
    v_exp_f32 v121, v121
    v_exp_f32 v122, v122
    v_exp_f32 v123, v123
    v_exp_f32 v124, v124
    s_waitcnt vmcnt(27)
    v_smfmac_f32_32x32x32_bf16 v[48:63], v[156:159], v[112:119], v7
    v_exp_f32 v125, v125
    v_exp_f32 v126, v126
    v_exp_f32 v127, v127
    v_exp_f32 v80, v80
    v_exp_f32 v81, v81
    v_exp_f32 v82, v82
    v_smfmac_f32_32x32x32_bf16 v[48:63], v[160:163], v[120:127], v7
    v_exp_f32 v83, v83
    v_exp_f32 v84, v84
    v_exp_f32 v85, v85
    s_add_u32 m0, s58, s56
    s_lshl_b32 s57, s56, 3
    s_add_u32 s57, s57, s59
    buffer_load_dwordx4 v226, s[20:23], s57 offen lds
    s_add_u32 s56, s56, 1024
    v_exp_f32 v86, v86
    v_exp_f32 v87, v87
    v_mfma_f32_32x32x16_bf16 v[112:127], v[164:167], v[12:15], v[32:47]
    v_exp_f32 v88, v88
    v_exp_f32 v89, v89
    v_exp_f32 v90, v90
    v_exp_f32 v91, v91
    v_exp_f32 v92, v92
    v_smfmac_f32_32x32x32_bf16 v[64:79], v[156:159], v[80:87], v7
    v_exp_f32 v93, v93
    v_exp_f32 v94, v94
    v_exp_f32 v95, v95
    v_exp_f32 v96, v96
    v_exp_f32 v97, v97
    v_exp_f32 v98, v98
    v_smfmac_f32_32x32x32_bf16 v[64:79], v[160:163], v[88:95], v7
    v_exp_f32 v99, v99
    v_exp_f32 v100, v100
    v_exp_f32 v101, v101
    buffer_store_dwordx4 v[228:231], v2, s[24:27], s89 offen offset:1024 sc1
    s_setprio 0
    v_exp_f32 v102, v102
    v_exp_f32 v103, v103
    s_waitcnt vmcnt(24)
    v_mfma_f32_32x32x16_bf16 v[80:95], v[176:179], v[8:11], v[16:31]
    v_exp_f32 v104, v104
    v_exp_f32 v105, v105
    v_exp_f32 v106, v106
    v_exp_f32 v107, v107
    v_exp_f32 v108, v108
    v_smfmac_f32_32x32x32_bf16 v[48:63], v[168:171], v[96:103], v7
    v_exp_f32 v109, v109
    v_exp_f32 v110, v110
    v_exp_f32 v111, v111
    v_exp_f32 v112, v112
    v_exp_f32 v113, v113
    v_exp_f32 v114, v114
    v_smfmac_f32_32x32x32_bf16 v[48:63], v[172:175], v[104:111], v7
    v_exp_f32 v115, v115
    v_exp_f32 v116, v116
    v_exp_f32 v117, v117
    v_exp_f32 v118, v118
    v_exp_f32 v119, v119
    v_mfma_f32_32x32x16_bf16 v[96:111], v[176:179], v[12:15], v[32:47]
    v_exp_f32 v120, v120
    v_exp_f32 v121, v121
    v_exp_f32 v122, v122
    v_exp_f32 v123, v123
    v_exp_f32 v124, v124
    v_smfmac_f32_32x32x32_bf16 v[64:79], v[168:171], v[112:119], v7
    v_exp_f32 v125, v125
    v_exp_f32 v126, v126
    v_exp_f32 v127, v127
    v_exp_f32 v80, v80
    v_exp_f32 v81, v81
    v_exp_f32 v82, v82
    v_smfmac_f32_32x32x32_bf16 v[64:79], v[172:175], v[120:127], v7
    v_exp_f32 v83, v83
    v_exp_f32 v84, v84
    v_exp_f32 v85, v85
    buffer_load_dwordx4 v[152:155], v6, s[28:31], s54 offen offset:0 sc1
    buffer_load_dwordx4 v[164:167], v6, s[28:31], s54 offen offset:2048 sc1
    s_mov_b64 exec, s[60:61]
    buffer_load_dwordx4 v[156:159], v3, s[28:31], s54 offen offset:1024 sc1
    buffer_load_dwordx4 v[160:163], v3, s[28:31], s54 offen offset:1536 sc1
    buffer_load_dwordx4 v[168:171], v3, s[28:31], s54 offen offset:3072 sc1
    buffer_load_dwordx4 v[172:175], v3, s[28:31], s54 offen offset:3584 sc1
    s_mov_b64 exec, -1
    s_add_u32 s54, s54, 4096
    s_setprio 3
    v_exp_f32 v86, v86
    v_exp_f32 v87, v87
    s_waitcnt vmcnt(29)
    v_mfma_f32_32x32x16_bf16 v[112:127], v[188:191], v[8:11], v[16:31]
    v_exp_f32 v88, v88
    v_exp_f32 v89, v89
    v_exp_f32 v90, v90
    v_exp_f32 v91, v91
    v_exp_f32 v92, v92
    s_waitcnt vmcnt(27)
    v_smfmac_f32_32x32x32_bf16 v[48:63], v[180:183], v[80:87], v7
    v_exp_f32 v93, v93
    v_exp_f32 v94, v94
    v_exp_f32 v95, v95
    v_exp_f32 v96, v96
    v_exp_f32 v97, v97
    v_exp_f32 v98, v98
    v_smfmac_f32_32x32x32_bf16 v[48:63], v[184:187], v[88:95], v7
    v_exp_f32 v99, v99
    v_exp_f32 v100, v100
    v_exp_f32 v101, v101
    s_add_u32 m0, s58, s56
    s_lshl_b32 s57, s56, 3
    s_add_u32 s57, s57, s59
    buffer_load_dwordx4 v226, s[20:23], s57 offen lds
    s_add_u32 s56, s56, 1024
    v_exp_f32 v102, v102
    v_exp_f32 v103, v103
    v_mfma_f32_32x32x16_bf16 v[80:95], v[188:191], v[12:15], v[32:47]
    v_exp_f32 v104, v104
    v_exp_f32 v105, v105
    v_exp_f32 v106, v106
    v_exp_f32 v107, v107
    v_exp_f32 v108, v108
    v_smfmac_f32_32x32x32_bf16 v[64:79], v[180:183], v[96:103], v7
    v_exp_f32 v109, v109
    v_exp_f32 v110, v110
    v_exp_f32 v111, v111
    v_exp_f32 v112, v112
    v_exp_f32 v113, v113
    v_exp_f32 v114, v114
    v_smfmac_f32_32x32x32_bf16 v[64:79], v[184:187], v[104:111], v7
    v_exp_f32 v115, v115
    v_exp_f32 v116, v116
    v_exp_f32 v117, v117
    s_setprio 2
    v_exp_f32 v118, v118
    v_exp_f32 v119, v119
    s_waitcnt vmcnt(22)
    v_mfma_f32_32x32x16_bf16 v[96:111], v[200:203], v[8:11], v[16:31]
    v_exp_f32 v120, v120
    v_exp_f32 v121, v121
    v_exp_f32 v122, v122
    v_exp_f32 v123, v123
    v_exp_f32 v124, v124
    v_smfmac_f32_32x32x32_bf16 v[48:63], v[192:195], v[112:119], v7
    v_exp_f32 v125, v125
    v_exp_f32 v126, v126
    v_exp_f32 v127, v127
    v_exp_f32 v80, v80
    v_exp_f32 v81, v81
    v_exp_f32 v82, v82
    v_smfmac_f32_32x32x32_bf16 v[48:63], v[196:199], v[120:127], v7
    v_exp_f32 v83, v83
    v_exp_f32 v84, v84
    v_exp_f32 v85, v85
    s_add_u32 m0, s58, s56
    s_lshl_b32 s57, s56, 3
    s_add_u32 s57, s57, s59
    buffer_load_dwordx4 v226, s[20:23], s57 offen lds
    s_add_u32 s56, s56, 1024
    v_exp_f32 v86, v86
    v_exp_f32 v87, v87
    v_mfma_f32_32x32x16_bf16 v[112:127], v[200:203], v[12:15], v[32:47]
    v_exp_f32 v88, v88
    v_exp_f32 v89, v89
    v_exp_f32 v90, v90
    v_exp_f32 v91, v91
    v_exp_f32 v92, v92
    v_smfmac_f32_32x32x32_bf16 v[64:79], v[192:195], v[80:87], v7
    v_exp_f32 v93, v93
    v_exp_f32 v94, v94
    v_exp_f32 v95, v95
    v_exp_f32 v96, v96
    v_exp_f32 v97, v97
    v_exp_f32 v98, v98
    v_smfmac_f32_32x32x32_bf16 v[64:79], v[196:199], v[88:95], v7
    v_exp_f32 v99, v99
    v_exp_f32 v100, v100
    v_exp_f32 v101, v101
    buffer_load_dwordx4 v[176:179], v6, s[28:31], s54 offen offset:0 sc1
    buffer_load_dwordx4 v[188:191], v6, s[28:31], s54 offen offset:2048 sc1
    s_mov_b64 exec, s[60:61]
    buffer_load_dwordx4 v[180:183], v3, s[28:31], s54 offen offset:1024 sc1
    buffer_load_dwordx4 v[184:187], v3, s[28:31], s54 offen offset:1536 sc1
    buffer_load_dwordx4 v[192:195], v3, s[28:31], s54 offen offset:3072 sc1
    buffer_load_dwordx4 v[196:199], v3, s[28:31], s54 offen offset:3584 sc1
    s_mov_b64 exec, -1
    s_add_u32 s54, s54, 4096
    s_setprio 1
    v_exp_f32 v102, v102
    v_exp_f32 v103, v103
    s_waitcnt vmcnt(28)
    v_mfma_f32_32x32x16_bf16 v[80:95], v[212:215], v[8:11], v[16:31]
    v_exp_f32 v104, v104
    v_exp_f32 v105, v105
    v_exp_f32 v106, v106
    v_exp_f32 v107, v107
    v_exp_f32 v108, v108
    s_waitcnt vmcnt(26)
    v_smfmac_f32_32x32x32_bf16 v[48:63], v[204:207], v[96:103], v7
    v_exp_f32 v109, v109
    v_exp_f32 v110, v110
    v_exp_f32 v111, v111
    v_exp_f32 v112, v112
    v_exp_f32 v113, v113
    v_exp_f32 v114, v114
    v_smfmac_f32_32x32x32_bf16 v[48:63], v[208:211], v[104:111], v7
    v_exp_f32 v115, v115
    v_exp_f32 v116, v116
    v_exp_f32 v117, v117
    s_add_u32 m0, s58, s56
    s_lshl_b32 s57, s56, 3
    s_add_u32 s57, s57, s59
    buffer_load_dwordx4 v226, s[20:23], s57 offen lds
    s_add_u32 s56, s56, 1024
    v_exp_f32 v118, v118
    v_exp_f32 v119, v119
    v_mfma_f32_32x32x16_bf16 v[96:111], v[212:215], v[12:15], v[32:47]
    v_exp_f32 v120, v120
    v_exp_f32 v121, v121
    v_exp_f32 v122, v122
    v_exp_f32 v123, v123
    v_exp_f32 v124, v124
    v_smfmac_f32_32x32x32_bf16 v[64:79], v[204:207], v[112:119], v7
    v_exp_f32 v125, v125
    v_exp_f32 v126, v126
    v_exp_f32 v127, v127
    v_exp_f32 v80, v80
    v_exp_f32 v81, v81
    v_exp_f32 v82, v82
    v_smfmac_f32_32x32x32_bf16 v[64:79], v[208:211], v[120:127], v7
    v_exp_f32 v83, v83
    v_exp_f32 v84, v84
    v_exp_f32 v85, v85
    s_setprio 0
    v_exp_f32 v86, v86
    v_exp_f32 v87, v87
    s_waitcnt vmcnt(22)
    v_mfma_f32_32x32x16_bf16 v[112:127], v[128:131], v[8:11], v[16:31]
    v_exp_f32 v88, v88
    v_exp_f32 v89, v89
    v_exp_f32 v90, v90
    v_exp_f32 v91, v91
    v_exp_f32 v92, v92
    v_smfmac_f32_32x32x32_bf16 v[48:63], v[216:219], v[80:87], v7
    v_exp_f32 v93, v93
    v_exp_f32 v94, v94
    v_exp_f32 v95, v95
    v_exp_f32 v96, v96
    v_exp_f32 v97, v97
    v_exp_f32 v98, v98
    v_smfmac_f32_32x32x32_bf16 v[48:63], v[220:223], v[88:95], v7
    v_exp_f32 v99, v99
    v_exp_f32 v100, v100
    v_exp_f32 v101, v101
    v_exp_f32 v102, v102
    v_exp_f32 v103, v103
    v_mfma_f32_32x32x16_bf16 v[80:95], v[128:131], v[12:15], v[32:47]
    v_exp_f32 v104, v104
    v_exp_f32 v105, v105
    v_exp_f32 v106, v106
    v_exp_f32 v107, v107
    v_exp_f32 v108, v108
    v_smfmac_f32_32x32x32_bf16 v[64:79], v[216:219], v[96:103], v7
    v_exp_f32 v109, v109
    v_exp_f32 v110, v110
    v_exp_f32 v111, v111
    v_exp_f32 v112, v112
    v_exp_f32 v113, v113
    v_exp_f32 v114, v114
    v_smfmac_f32_32x32x32_bf16 v[64:79], v[220:223], v[104:111], v7
    v_exp_f32 v115, v115
    v_exp_f32 v116, v116
    v_exp_f32 v117, v117
    buffer_load_dwordx4 v[200:203], v6, s[28:31], s54 offen offset:0 sc1
    buffer_load_dwordx4 v[212:215], v6, s[28:31], s54 offen offset:2048 sc1
    s_mov_b64 exec, s[60:61]
    buffer_load_dwordx4 v[204:207], v3, s[28:31], s54 offen offset:1024 sc1
    buffer_load_dwordx4 v[208:211], v3, s[28:31], s54 offen offset:1536 sc1
    buffer_load_dwordx4 v[216:219], v3, s[28:31], s54 offen offset:3072 sc1
    buffer_load_dwordx4 v[220:223], v3, s[28:31], s54 offen offset:3584 sc1
    s_mov_b64 exec, -1
    s_add_u32 s54, s54, 4096
    s_setprio 3
    v_exp_f32 v118, v118
    v_exp_f32 v119, v119
    s_waitcnt vmcnt(27)
    v_mfma_f32_32x32x16_bf16 v[96:111], v[140:143], v[8:11], v[16:31]
    v_exp_f32 v120, v120
    v_exp_f32 v121, v121
    v_exp_f32 v122, v122
    v_exp_f32 v123, v123
    v_exp_f32 v124, v124
    s_waitcnt vmcnt(25)
    v_smfmac_f32_32x32x32_bf16 v[48:63], v[132:135], v[112:119], v7
    v_exp_f32 v125, v125
    v_exp_f32 v126, v126
    v_exp_f32 v127, v127
    v_exp_f32 v80, v80
    v_exp_f32 v81, v81
    v_exp_f32 v82, v82
    v_smfmac_f32_32x32x32_bf16 v[48:63], v[136:139], v[120:127], v7
    v_exp_f32 v83, v83
    v_exp_f32 v84, v84
    v_exp_f32 v85, v85
    s_add_u32 m0, s58, s56
    s_lshl_b32 s57, s56, 3
    s_add_u32 s57, s57, s59
    buffer_load_dwordx4 v226, s[20:23], s57 offen lds
    s_add_u32 s56, s56, 1024
    v_exp_f32 v86, v86
    v_exp_f32 v87, v87
    v_mfma_f32_32x32x16_bf16 v[112:127], v[140:143], v[12:15], v[32:47]
    v_exp_f32 v88, v88
    v_exp_f32 v89, v89
    v_exp_f32 v90, v90
    v_exp_f32 v91, v91
    v_exp_f32 v92, v92
    v_smfmac_f32_32x32x32_bf16 v[64:79], v[132:135], v[80:87], v7
    v_exp_f32 v93, v93
    v_exp_f32 v94, v94
    v_exp_f32 v95, v95
    v_exp_f32 v96, v96
    v_exp_f32 v97, v97
    v_exp_f32 v98, v98
    v_smfmac_f32_32x32x32_bf16 v[64:79], v[136:139], v[88:95], v7
    v_exp_f32 v99, v99
    v_exp_f32 v100, v100
    v_exp_f32 v101, v101
    v_mov_b32 v228, s76
    v_mov_b32 v229, s77
    v_mov_b32 v230, 0
    s_mov_b64 exec, 1
    buffer_store_dwordx2 v[228:229], v230, s[28:31], s3 offen sc1
    s_mov_b64 exec, -1
    s_waitcnt vmcnt(23)
    v_mov_b32 v228, 1
    v_cndmask_b32 v228, v228, 0, s[94:95]
    s_mov_b64 exec, 1
    ds_add_u32 v224, v228 offset:0
    s_mov_b64 exec, -1
    s_setprio 2
    v_exp_f32 v102, v102
    v_exp_f32 v103, v103
    s_waitcnt vmcnt(22)
    v_mfma_f32_32x32x16_bf16 v[80:95], v[152:155], v[8:11], v[16:31]
    v_exp_f32 v104, v104
    v_exp_f32 v105, v105
    v_exp_f32 v106, v106
    v_exp_f32 v107, v107
    v_exp_f32 v108, v108
    v_smfmac_f32_32x32x32_bf16 v[48:63], v[144:147], v[96:103], v7
    v_exp_f32 v109, v109
    v_exp_f32 v110, v110
    v_exp_f32 v111, v111
    v_exp_f32 v112, v112
    v_exp_f32 v113, v113
    v_exp_f32 v114, v114
    v_smfmac_f32_32x32x32_bf16 v[48:63], v[148:151], v[104:111], v7
    v_exp_f32 v115, v115
    v_exp_f32 v116, v116
    v_exp_f32 v117, v117
    s_add_u32 m0, s58, s56
    s_lshl_b32 s57, s56, 3
    s_add_u32 s57, s57, s59
    buffer_load_dwordx4 v226, s[20:23], s57 offen lds
    s_add_u32 s56, s56, 1024
    v_exp_f32 v118, v118
    v_exp_f32 v119, v119
    v_mfma_f32_32x32x16_bf16 v[96:111], v[152:155], v[12:15], v[32:47]
    v_exp_f32 v120, v120
    v_exp_f32 v121, v121
    v_exp_f32 v122, v122
    v_exp_f32 v123, v123
    v_exp_f32 v124, v124
    v_smfmac_f32_32x32x32_bf16 v[64:79], v[144:147], v[112:119], v7
    v_exp_f32 v125, v125
    v_exp_f32 v126, v126
    v_exp_f32 v127, v127
    v_exp_f32 v80, v80
    v_exp_f32 v81, v81
    v_exp_f32 v82, v82
    v_smfmac_f32_32x32x32_bf16 v[64:79], v[148:151], v[120:127], v7
    v_exp_f32 v83, v83
    v_exp_f32 v84, v84
    v_exp_f32 v85, v85
    buffer_load_dwordx4 v[128:131], v6, s[28:31], s54 offen offset:0 sc1
    buffer_load_dwordx4 v[140:143], v6, s[28:31], s54 offen offset:2048 sc1
    s_mov_b64 exec, s[60:61]
    buffer_load_dwordx4 v[132:135], v3, s[28:31], s54 offen offset:1024 sc1
    buffer_load_dwordx4 v[136:139], v3, s[28:31], s54 offen offset:1536 sc1
    buffer_load_dwordx4 v[144:147], v3, s[28:31], s54 offen offset:3072 sc1
    buffer_load_dwordx4 v[148:151], v3, s[28:31], s54 offen offset:3584 sc1
    s_mov_b64 exec, -1
    s_add_u32 s54, s54, 4096
    s_setprio 1
    v_exp_f32 v86, v86
    v_exp_f32 v87, v87
    s_waitcnt vmcnt(28)
    v_mfma_f32_32x32x16_bf16 v[112:127], v[164:167], v[8:11], v[16:31]
    v_exp_f32 v88, v88
    v_exp_f32 v89, v89
    v_exp_f32 v90, v90
    v_exp_f32 v91, v91
    v_exp_f32 v92, v92
    s_waitcnt vmcnt(26)
    v_smfmac_f32_32x32x32_bf16 v[48:63], v[156:159], v[80:87], v7
    v_exp_f32 v93, v93
    v_exp_f32 v94, v94
    v_exp_f32 v95, v95
    v_exp_f32 v96, v96
    v_exp_f32 v97, v97
    v_exp_f32 v98, v98
    v_smfmac_f32_32x32x32_bf16 v[48:63], v[160:163], v[88:95], v7
    v_exp_f32 v99, v99
    v_exp_f32 v100, v100
    v_exp_f32 v101, v101
    v_exp_f32 v102, v102
    v_exp_f32 v103, v103
    v_mfma_f32_32x32x16_bf16 v[80:95], v[164:167], v[12:15], v[32:47]
    v_exp_f32 v104, v104
    v_exp_f32 v105, v105
    v_exp_f32 v106, v106
    v_exp_f32 v107, v107
    v_exp_f32 v108, v108
    v_smfmac_f32_32x32x32_bf16 v[64:79], v[156:159], v[96:103], v7
    v_exp_f32 v109, v109
    v_exp_f32 v110, v110
    v_exp_f32 v111, v111
    v_exp_f32 v112, v112
    v_exp_f32 v113, v113
    v_exp_f32 v114, v114
    v_smfmac_f32_32x32x32_bf16 v[64:79], v[160:163], v[104:111], v7
    v_exp_f32 v115, v115
    v_exp_f32 v116, v116
    v_exp_f32 v117, v117
    s_setprio 0
    v_exp_f32 v118, v118
    v_exp_f32 v119, v119
    s_waitcnt vmcnt(21)
    v_mfma_f32_32x32x16_bf16 v[96:111], v[176:179], v[8:11], v[16:31]
    v_exp_f32 v120, v120
    v_exp_f32 v121, v121
    v_exp_f32 v122, v122
    v_exp_f32 v123, v123
    v_exp_f32 v124, v124
    v_smfmac_f32_32x32x32_bf16 v[48:63], v[168:171], v[112:119], v7
    v_exp_f32 v125, v125
    v_exp_f32 v126, v126
    v_exp_f32 v127, v127
    v_exp_f32 v80, v80
    v_exp_f32 v81, v81
    v_exp_f32 v82, v82
    v_smfmac_f32_32x32x32_bf16 v[48:63], v[172:175], v[120:127], v7
    v_exp_f32 v83, v83
    v_exp_f32 v84, v84
    v_exp_f32 v85, v85
    s_add_u32 m0, s58, s56
    s_lshl_b32 s57, s56, 3
    s_add_u32 s57, s57, s59
    buffer_load_dwordx4 v226, s[20:23], s57 offen lds
    s_add_u32 s56, s56, 1024
    v_exp_f32 v86, v86
    v_exp_f32 v87, v87
    v_mfma_f32_32x32x16_bf16 v[112:127], v[176:179], v[12:15], v[32:47]
    v_exp_f32 v88, v88
    v_exp_f32 v89, v89
    v_exp_f32 v90, v90
    v_exp_f32 v91, v91
    v_exp_f32 v92, v92
    v_smfmac_f32_32x32x32_bf16 v[64:79], v[168:171], v[80:87], v7
    v_exp_f32 v93, v93
    v_exp_f32 v94, v94
    v_exp_f32 v95, v95
    v_exp_f32 v96, v96
    v_exp_f32 v97, v97
    v_exp_f32 v98, v98
    v_smfmac_f32_32x32x32_bf16 v[64:79], v[172:175], v[88:95], v7
    v_exp_f32 v99, v99
    v_exp_f32 v100, v100
    v_exp_f32 v101, v101
    buffer_load_dwordx4 v[152:155], v6, s[28:31], s54 offen offset:0 sc1
    buffer_load_dwordx4 v[164:167], v6, s[28:31], s54 offen offset:2048 sc1
    s_mov_b64 exec, s[60:61]
    buffer_load_dwordx4 v[156:159], v3, s[28:31], s54 offen offset:1024 sc1
    buffer_load_dwordx4 v[160:163], v3, s[28:31], s54 offen offset:1536 sc1
    buffer_load_dwordx4 v[168:171], v3, s[28:31], s54 offen offset:3072 sc1
    buffer_load_dwordx4 v[172:175], v3, s[28:31], s54 offen offset:3584 sc1
    s_mov_b64 exec, -1
    s_add_u32 s54, s54, 4096
    s_setprio 3
    v_exp_f32 v102, v102
    v_exp_f32 v103, v103
    s_waitcnt vmcnt(27)
    v_mfma_f32_32x32x16_bf16 v[80:95], v[188:191], v[8:11], v[16:31]
    v_exp_f32 v104, v104
    v_exp_f32 v105, v105
    v_exp_f32 v106, v106
    v_exp_f32 v107, v107
    v_exp_f32 v108, v108
    s_waitcnt vmcnt(25)
    v_smfmac_f32_32x32x32_bf16 v[48:63], v[180:183], v[96:103], v7
    v_exp_f32 v109, v109
    v_exp_f32 v110, v110
    v_exp_f32 v111, v111
    v_exp_f32 v112, v112
    v_exp_f32 v113, v113
    v_exp_f32 v114, v114
    v_smfmac_f32_32x32x32_bf16 v[48:63], v[184:187], v[104:111], v7
    v_exp_f32 v115, v115
    v_exp_f32 v116, v116
    v_exp_f32 v117, v117
    s_add_u32 m0, s58, s56
    s_lshl_b32 s57, s56, 3
    s_add_u32 s57, s57, s59
    buffer_load_dwordx4 v226, s[20:23], s57 offen lds
    s_add_u32 s56, s56, 1024
    v_exp_f32 v118, v118
    v_exp_f32 v119, v119
    v_mfma_f32_32x32x16_bf16 v[96:111], v[188:191], v[12:15], v[32:47]
    v_exp_f32 v120, v120
    v_exp_f32 v121, v121
    v_exp_f32 v122, v122
    v_exp_f32 v123, v123
    v_exp_f32 v124, v124
    v_smfmac_f32_32x32x32_bf16 v[64:79], v[180:183], v[112:119], v7
    v_exp_f32 v125, v125
    v_exp_f32 v126, v126
    v_exp_f32 v127, v127
    v_exp_f32 v80, v80
    v_exp_f32 v81, v81
    v_exp_f32 v82, v82
    v_smfmac_f32_32x32x32_bf16 v[64:79], v[184:187], v[120:127], v7
    v_exp_f32 v83, v83
    v_exp_f32 v84, v84
    v_exp_f32 v85, v85
    s_setprio 2
    v_exp_f32 v86, v86
    v_exp_f32 v87, v87
    s_waitcnt vmcnt(22)
    v_mfma_f32_32x32x16_bf16 v[112:127], v[200:203], v[8:11], v[16:31]
    v_exp_f32 v88, v88
    v_exp_f32 v89, v89
    v_exp_f32 v90, v90
    v_exp_f32 v91, v91
    v_exp_f32 v92, v92
    v_smfmac_f32_32x32x32_bf16 v[48:63], v[192:195], v[80:87], v7
    v_exp_f32 v93, v93
    v_exp_f32 v94, v94
    v_exp_f32 v95, v95
    v_exp_f32 v96, v96
    v_exp_f32 v97, v97
    v_exp_f32 v98, v98
    v_smfmac_f32_32x32x32_bf16 v[48:63], v[196:199], v[88:95], v7
    v_exp_f32 v99, v99
    v_exp_f32 v100, v100
    v_exp_f32 v101, v101
    v_exp_f32 v102, v102
    v_exp_f32 v103, v103
    v_mfma_f32_32x32x16_bf16 v[80:95], v[200:203], v[12:15], v[32:47]
    v_exp_f32 v104, v104
    v_exp_f32 v105, v105
    v_exp_f32 v106, v106
    v_exp_f32 v107, v107
    v_exp_f32 v108, v108
    v_smfmac_f32_32x32x32_bf16 v[64:79], v[192:195], v[96:103], v7
    v_exp_f32 v109, v109
    v_exp_f32 v110, v110
    v_exp_f32 v111, v111
    v_exp_f32 v112, v112
    v_exp_f32 v113, v113
    v_exp_f32 v114, v114
    v_smfmac_f32_32x32x32_bf16 v[64:79], v[196:199], v[104:111], v7
    v_exp_f32 v115, v115
    v_exp_f32 v116, v116
    v_exp_f32 v117, v117
    buffer_load_dwordx4 v[176:179], v6, s[28:31], s54 offen offset:0 sc1
    buffer_load_dwordx4 v[188:191], v6, s[28:31], s54 offen offset:2048 sc1
    s_mov_b64 exec, s[60:61]
    buffer_load_dwordx4 v[180:183], v3, s[28:31], s54 offen offset:1024 sc1
    buffer_load_dwordx4 v[184:187], v3, s[28:31], s54 offen offset:1536 sc1
    buffer_load_dwordx4 v[192:195], v3, s[28:31], s54 offen offset:3072 sc1
    buffer_load_dwordx4 v[196:199], v3, s[28:31], s54 offen offset:3584 sc1
    s_mov_b64 exec, -1
    s_add_u32 s54, s54, 4096
    s_setprio 1
    v_exp_f32 v118, v118
    v_exp_f32 v119, v119
    s_waitcnt vmcnt(27)
    v_mfma_f32_32x32x16_bf16 v[96:111], v[212:215], v[8:11], v[16:31]
    v_exp_f32 v120, v120
    v_exp_f32 v121, v121
    v_exp_f32 v122, v122
    v_exp_f32 v123, v123
    v_exp_f32 v124, v124
    s_waitcnt vmcnt(25)
    v_smfmac_f32_32x32x32_bf16 v[48:63], v[204:207], v[112:119], v7
    v_exp_f32 v125, v125
    v_exp_f32 v126, v126
    v_exp_f32 v127, v127
    v_exp_f32 v80, v80
    v_exp_f32 v81, v81
    v_exp_f32 v82, v82
    v_smfmac_f32_32x32x32_bf16 v[48:63], v[208:211], v[120:127], v7
    v_exp_f32 v83, v83
    v_exp_f32 v84, v84
    v_exp_f32 v85, v85
    s_add_u32 m0, s58, s56
    s_lshl_b32 s57, s56, 3
    s_add_u32 s57, s57, s59
    buffer_load_dwordx4 v226, s[20:23], s57 offen lds
    s_add_u32 s56, s56, 1024
    v_exp_f32 v86, v86
    v_exp_f32 v87, v87
    v_mfma_f32_32x32x16_bf16 v[112:127], v[212:215], v[12:15], v[32:47]
    v_exp_f32 v88, v88
    v_exp_f32 v89, v89
    v_exp_f32 v90, v90
    v_exp_f32 v91, v91
    v_exp_f32 v92, v92
    v_smfmac_f32_32x32x32_bf16 v[64:79], v[204:207], v[80:87], v7
    v_exp_f32 v93, v93
    v_exp_f32 v94, v94
    v_exp_f32 v95, v95
    v_exp_f32 v96, v96
    v_exp_f32 v97, v97
    v_exp_f32 v98, v98
    v_smfmac_f32_32x32x32_bf16 v[64:79], v[208:211], v[88:95], v7
    v_exp_f32 v99, v99
    v_exp_f32 v100, v100
    v_exp_f32 v101, v101
    s_setprio 0
    v_exp_f32 v102, v102
    v_exp_f32 v103, v103
    s_waitcnt vmcnt(20)
    v_mfma_f32_32x32x16_bf16 v[80:95], v[128:131], v[8:11], v[16:31]
    v_exp_f32 v104, v104
    v_exp_f32 v105, v105
    v_exp_f32 v106, v106
    v_exp_f32 v107, v107
    v_exp_f32 v108, v108
    v_smfmac_f32_32x32x32_bf16 v[48:63], v[216:219], v[96:103], v7
    v_exp_f32 v109, v109
    v_exp_f32 v110, v110
    v_exp_f32 v111, v111
    v_exp_f32 v112, v112
    v_exp_f32 v113, v113
    v_exp_f32 v114, v114
    v_smfmac_f32_32x32x32_bf16 v[48:63], v[220:223], v[104:111], v7
    v_exp_f32 v115, v115
    v_exp_f32 v116, v116
    v_exp_f32 v117, v117
    s_add_u32 m0, s58, s56
    s_lshl_b32 s57, s56, 3
    s_add_u32 s57, s57, s59
    buffer_load_dwordx4 v226, s[20:23], s57 offen lds
    s_add_u32 s56, s56, 1024
    v_exp_f32 v118, v118
    v_exp_f32 v119, v119
    v_mfma_f32_32x32x16_bf16 v[96:111], v[128:131], v[12:15], v[32:47]
    v_exp_f32 v120, v120
    v_exp_f32 v121, v121
    v_exp_f32 v122, v122
    v_exp_f32 v123, v123
    v_exp_f32 v124, v124
    v_smfmac_f32_32x32x32_bf16 v[64:79], v[216:219], v[112:119], v7
    v_exp_f32 v125, v125
    v_exp_f32 v126, v126
    v_exp_f32 v127, v127
    v_exp_f32 v80, v80
    v_exp_f32 v81, v81
    v_exp_f32 v82, v82
    v_smfmac_f32_32x32x32_bf16 v[64:79], v[220:223], v[120:127], v7
    v_exp_f32 v83, v83
    v_exp_f32 v84, v84
    v_exp_f32 v85, v85
    buffer_load_dwordx4 v[200:203], v6, s[28:31], s54 offen offset:0 sc1
    buffer_load_dwordx4 v[212:215], v6, s[28:31], s54 offen offset:2048 sc1
    s_mov_b64 exec, s[60:61]
    buffer_load_dwordx4 v[204:207], v3, s[28:31], s54 offen offset:1024 sc1
    buffer_load_dwordx4 v[208:211], v3, s[28:31], s54 offen offset:1536 sc1
    buffer_load_dwordx4 v[216:219], v3, s[28:31], s54 offen offset:3072 sc1
    buffer_load_dwordx4 v[220:223], v3, s[28:31], s54 offen offset:3584 sc1
    s_mov_b64 exec, -1
    s_add_u32 s54, s54, 4096
    s_setprio 3
    v_exp_f32 v86, v86
    v_exp_f32 v87, v87
    s_waitcnt vmcnt(26)
    v_mfma_f32_32x32x16_bf16 v[112:127], v[140:143], v[8:11], v[16:31]
    v_exp_f32 v88, v88
    v_exp_f32 v89, v89
    v_exp_f32 v90, v90
    v_exp_f32 v91, v91
    v_exp_f32 v92, v92
    s_waitcnt vmcnt(24)
    v_smfmac_f32_32x32x32_bf16 v[48:63], v[132:135], v[80:87], v7
    v_exp_f32 v93, v93
    v_exp_f32 v94, v94
    v_exp_f32 v95, v95
    v_exp_f32 v96, v96
    v_exp_f32 v97, v97
    v_exp_f32 v98, v98
    v_smfmac_f32_32x32x32_bf16 v[48:63], v[136:139], v[88:95], v7
    v_exp_f32 v99, v99
    v_exp_f32 v100, v100
    v_exp_f32 v101, v101
    v_exp_f32 v102, v102
    v_exp_f32 v103, v103
    v_mfma_f32_32x32x16_bf16 v[80:95], v[140:143], v[12:15], v[32:47]
    v_exp_f32 v104, v104
    v_exp_f32 v105, v105
    v_exp_f32 v106, v106
    v_exp_f32 v107, v107
    v_exp_f32 v108, v108
    v_smfmac_f32_32x32x32_bf16 v[64:79], v[132:135], v[96:103], v7
    v_exp_f32 v109, v109
    v_exp_f32 v110, v110
    v_exp_f32 v111, v111
    v_exp_f32 v112, v112
    v_exp_f32 v113, v113
    v_exp_f32 v114, v114
    v_smfmac_f32_32x32x32_bf16 v[64:79], v[136:139], v[104:111], v7
    v_exp_f32 v115, v115
    v_exp_f32 v116, v116
    v_exp_f32 v117, v117
    s_setprio 2
    v_exp_f32 v118, v118
    v_exp_f32 v119, v119
    s_waitcnt vmcnt(20)
    v_mfma_f32_32x32x16_bf16 v[96:111], v[152:155], v[8:11], v[16:31]
    v_exp_f32 v120, v120
    v_exp_f32 v121, v121
    v_exp_f32 v122, v122
    v_exp_f32 v123, v123
    v_exp_f32 v124, v124
    v_smfmac_f32_32x32x32_bf16 v[48:63], v[144:147], v[112:119], v7
    v_exp_f32 v125, v125
    v_exp_f32 v126, v126
    v_exp_f32 v127, v127
    v_exp_f32 v80, v80
    v_exp_f32 v81, v81
    v_exp_f32 v82, v82
    v_smfmac_f32_32x32x32_bf16 v[48:63], v[148:151], v[120:127], v7
    v_exp_f32 v83, v83
    v_exp_f32 v84, v84
    v_exp_f32 v85, v85
    v_mov_b32 v230, 0
    buffer_load_dwordx2 v[228:229], v230, s[28:31], s88 offen sc1
    v_exp_f32 v86, v86
    v_exp_f32 v87, v87
    v_mfma_f32_32x32x16_bf16 v[112:127], v[152:155], v[12:15], v[32:47]
    v_exp_f32 v88, v88
    v_exp_f32 v89, v89
    v_exp_f32 v90, v90
    v_exp_f32 v91, v91
    v_exp_f32 v92, v92
    v_smfmac_f32_32x32x32_bf16 v[64:79], v[144:147], v[80:87], v7
    v_exp_f32 v93, v93
    v_exp_f32 v94, v94
    v_exp_f32 v95, v95
    v_exp_f32 v96, v96
    v_exp_f32 v97, v97
    v_exp_f32 v98, v98
    v_smfmac_f32_32x32x32_bf16 v[64:79], v[148:151], v[88:95], v7
    v_exp_f32 v99, v99
    v_exp_f32 v100, v100
    v_exp_f32 v101, v101
    s_setprio 1
    v_exp_f32 v102, v102
    v_exp_f32 v103, v103
    s_waitcnt vmcnt(20)
    v_mfma_f32_32x32x16_bf16 v[80:95], v[164:167], v[8:11], v[16:31]
    v_exp_f32 v104, v104
    v_exp_f32 v105, v105
    v_exp_f32 v106, v106
    v_exp_f32 v107, v107
    v_exp_f32 v108, v108
    s_waitcnt vmcnt(18)
    v_smfmac_f32_32x32x32_bf16 v[48:63], v[156:159], v[96:103], v7
    v_exp_f32 v109, v109
    v_exp_f32 v110, v110
    v_exp_f32 v111, v111
    v_exp_f32 v112, v112
    v_exp_f32 v113, v113
    v_exp_f32 v114, v114
    v_smfmac_f32_32x32x32_bf16 v[48:63], v[160:163], v[104:111], v7
    v_exp_f32 v115, v115
    v_exp_f32 v116, v116
    v_exp_f32 v117, v117
    v_exp_f32 v118, v118
    v_exp_f32 v119, v119
    v_mfma_f32_32x32x16_bf16 v[96:111], v[164:167], v[12:15], v[32:47]
    v_exp_f32 v120, v120
    v_exp_f32 v121, v121
    v_exp_f32 v122, v122
    v_exp_f32 v123, v123
    v_exp_f32 v124, v124
    v_smfmac_f32_32x32x32_bf16 v[64:79], v[156:159], v[112:119], v7
    v_exp_f32 v125, v125
    v_exp_f32 v126, v126
    v_exp_f32 v127, v127
    v_exp_f32 v80, v80
    v_exp_f32 v81, v81
    v_exp_f32 v82, v82
    v_smfmac_f32_32x32x32_bf16 v[64:79], v[160:163], v[120:127], v7
    v_exp_f32 v83, v83
    v_exp_f32 v84, v84
    v_exp_f32 v85, v85
    s_setprio 0
    v_exp_f32 v86, v86
    v_exp_f32 v87, v87
    s_waitcnt vmcnt(14)
    v_mfma_f32_32x32x16_bf16 v[112:127], v[176:179], v[8:11], v[16:31]
    v_exp_f32 v88, v88
    v_exp_f32 v89, v89
    v_exp_f32 v90, v90
    v_exp_f32 v91, v91
    v_exp_f32 v92, v92
    v_smfmac_f32_32x32x32_bf16 v[48:63], v[168:171], v[80:87], v7
    v_exp_f32 v93, v93
    v_exp_f32 v94, v94
    v_exp_f32 v95, v95
    v_exp_f32 v96, v96
    v_exp_f32 v97, v97
    v_exp_f32 v98, v98
    v_smfmac_f32_32x32x32_bf16 v[48:63], v[172:175], v[88:95], v7
    v_exp_f32 v99, v99
    v_exp_f32 v100, v100
    v_exp_f32 v101, v101
    v_exp_f32 v102, v102
    v_exp_f32 v103, v103
    v_mfma_f32_32x32x16_bf16 v[80:95], v[176:179], v[12:15], v[32:47]
    v_exp_f32 v104, v104
    v_exp_f32 v105, v105
    v_exp_f32 v106, v106
    v_exp_f32 v107, v107
    v_exp_f32 v108, v108
    v_smfmac_f32_32x32x32_bf16 v[64:79], v[168:171], v[96:103], v7
    v_exp_f32 v109, v109
    v_exp_f32 v110, v110
    v_exp_f32 v111, v111
    v_exp_f32 v112, v112
    v_exp_f32 v113, v113
    v_exp_f32 v114, v114
    v_smfmac_f32_32x32x32_bf16 v[64:79], v[172:175], v[104:111], v7
    v_exp_f32 v115, v115
    v_exp_f32 v116, v116
    v_exp_f32 v117, v117
    s_setprio 3
    v_exp_f32 v118, v118
    v_exp_f32 v119, v119
    s_waitcnt vmcnt(13)
    v_mfma_f32_32x32x16_bf16 v[96:111], v[188:191], v[8:11], v[16:31]
    v_exp_f32 v120, v120
    v_exp_f32 v121, v121
    v_exp_f32 v122, v122
    v_exp_f32 v123, v123
    v_exp_f32 v124, v124
    s_waitcnt vmcnt(11)
    v_smfmac_f32_32x32x32_bf16 v[48:63], v[180:183], v[112:119], v7
    v_exp_f32 v125, v125
    v_exp_f32 v126, v126
    v_exp_f32 v127, v127
    v_exp_f32 v80, v80
    v_exp_f32 v81, v81
    v_exp_f32 v82, v82
    v_smfmac_f32_32x32x32_bf16 v[48:63], v[184:187], v[120:127], v7
    v_exp_f32 v83, v83
    v_exp_f32 v84, v84
    v_exp_f32 v85, v85
    s_waitcnt vmcnt(0)
    v_cmp_ne_u64 vcc, s[76:77], v[228:229]
    s_cbranch_vccnz POLL9_S
POLLD9:
    buffer_load_dwordx4 v[128:131], v2, s[28:31], s79 offen offset:0 sc1
    buffer_load_dwordx4 v[132:135], v2, s[28:31], s79 offen offset:1024 sc1
    buffer_load_dwordx4 v[136:139], v2, s[28:31], s79 offen offset:2048 sc1
    buffer_load_dwordx2 v[228:229], v225, s[28:31], s75 offen sc1
    v_exp_f32 v86, v86
    v_exp_f32 v87, v87
    v_mfma_f32_32x32x16_bf16 v[112:127], v[188:191], v[12:15], v[32:47]
    v_exp_f32 v88, v88
    v_exp_f32 v89, v89
    v_exp_f32 v90, v90
    v_exp_f32 v91, v91
    v_exp_f32 v92, v92
    v_smfmac_f32_32x32x32_bf16 v[64:79], v[180:183], v[80:87], v7
    v_exp_f32 v93, v93
    v_exp_f32 v94, v94
    v_exp_f32 v95, v95
    v_exp_f32 v96, v96
    v_exp_f32 v97, v97
    v_exp_f32 v98, v98
    v_smfmac_f32_32x32x32_bf16 v[64:79], v[184:187], v[88:95], v7
    v_exp_f32 v99, v99
    v_exp_f32 v100, v100
    v_exp_f32 v101, v101
    s_setprio 2
    v_exp_f32 v102, v102
    v_exp_f32 v103, v103
    v_mfma_f32_32x32x16_bf16 v[80:95], v[200:203], v[8:11], v[16:31]
    v_exp_f32 v104, v104
    v_exp_f32 v105, v105
    v_exp_f32 v106, v106
    v_exp_f32 v107, v107
    v_exp_f32 v108, v108
    v_smfmac_f32_32x32x32_bf16 v[48:63], v[192:195], v[96:103], v7
    v_exp_f32 v109, v109
    v_exp_f32 v110, v110
    v_exp_f32 v111, v111
    v_exp_f32 v112, v112
    v_exp_f32 v113, v113
    v_exp_f32 v114, v114
    v_smfmac_f32_32x32x32_bf16 v[48:63], v[196:199], v[104:111], v7
    v_exp_f32 v115, v115
    v_exp_f32 v116, v116
    v_exp_f32 v117, v117
    v_exp_f32 v118, v118
    v_exp_f32 v119, v119
    v_mfma_f32_32x32x16_bf16 v[96:111], v[200:203], v[12:15], v[32:47]
    v_exp_f32 v120, v120
    v_exp_f32 v121, v121
    v_exp_f32 v122, v122
    v_exp_f32 v123, v123
    v_exp_f32 v124, v124
    v_smfmac_f32_32x32x32_bf16 v[64:79], v[192:195], v[112:119], v7
    v_exp_f32 v125, v125
    v_exp_f32 v126, v126
    v_exp_f32 v127, v127
    v_exp_f32 v80, v80
    v_exp_f32 v81, v81
    v_exp_f32 v82, v82
    v_smfmac_f32_32x32x32_bf16 v[64:79], v[196:199], v[120:127], v7
    v_exp_f32 v83, v83
    v_exp_f32 v84, v84
    v_exp_f32 v85, v85
    s_setprio 1
    v_exp_f32 v86, v86
    v_exp_f32 v87, v87
    v_mfma_f32_32x32x16_bf16 v[112:127], v[212:215], v[8:11], v[16:31]
    v_exp_f32 v88, v88
    v_exp_f32 v89, v89
    v_exp_f32 v90, v90
    v_exp_f32 v91, v91
    v_exp_f32 v92, v92
    v_smfmac_f32_32x32x32_bf16 v[48:63], v[204:207], v[80:87], v7
    v_exp_f32 v93, v93
    v_exp_f32 v94, v94
    v_exp_f32 v95, v95
    v_exp_f32 v96, v96
    v_exp_f32 v97, v97
    v_exp_f32 v98, v98
    v_smfmac_f32_32x32x32_bf16 v[48:63], v[208:211], v[88:95], v7
    v_exp_f32 v99, v99
    v_exp_f32 v100, v100
    v_exp_f32 v101, v101
    v_exp_f32 v102, v102
    v_exp_f32 v103, v103
    v_mfma_f32_32x32x16_bf16 v[80:95], v[212:215], v[12:15], v[32:47]
    v_exp_f32 v104, v104
    v_exp_f32 v105, v105
    v_exp_f32 v106, v106
    v_exp_f32 v107, v107
    v_exp_f32 v108, v108
    v_smfmac_f32_32x32x32_bf16 v[64:79], v[204:207], v[96:103], v7
    v_exp_f32 v109, v109
    v_exp_f32 v110, v110
    v_exp_f32 v111, v111
    v_exp_f32 v112, v112
    v_exp_f32 v113, v113
    v_exp_f32 v114, v114
    v_smfmac_f32_32x32x32_bf16 v[64:79], v[208:211], v[104:111], v7
    v_exp_f32 v115, v115
    v_exp_f32 v116, v116
    v_exp_f32 v117, v117
    s_setprio 0
    v_exp_f32 v118, v118
    v_exp_f32 v119, v119
    v_exp_f32 v120, v120
    v_exp_f32 v121, v121
    v_exp_f32 v122, v122
    v_exp_f32 v123, v123
    v_exp_f32 v124, v124
    v_smfmac_f32_32x32x32_bf16 v[48:63], v[216:219], v[112:119], v7
    v_exp_f32 v125, v125
    v_exp_f32 v126, v126
    v_exp_f32 v127, v127
    v_exp_f32 v80, v80
    v_exp_f32 v81, v81
    v_exp_f32 v82, v82
    v_smfmac_f32_32x32x32_bf16 v[48:63], v[220:223], v[120:127], v7
    v_exp_f32 v83, v83
    v_exp_f32 v84, v84
    v_exp_f32 v85, v85
    v_exp_f32 v86, v86
    v_exp_f32 v87, v87
    v_exp_f32 v88, v88
    v_exp_f32 v89, v89
    v_exp_f32 v90, v90
    v_exp_f32 v91, v91
    v_exp_f32 v92, v92
    v_smfmac_f32_32x32x32_bf16 v[64:79], v[216:219], v[80:87], v7
    v_exp_f32 v93, v93
    v_exp_f32 v94, v94
    v_exp_f32 v95, v95
    v_mov_b32 v112, 0x71800000
    v_mov_b32 v113, 0
    v_smfmac_f32_32x32x32_bf16 v[64:79], v[220:223], v[88:95], v7
    v_mov_b32 v114, 0x1c800000
    v_fma_f32 v113, v48, 0, v113
    v_fma_f32 v113, v49, 0, v113
    v_fma_f32 v113, v50, 0, v113
    v_fma_f32 v113, v51, 0, v113
    v_fma_f32 v113, v52, 0, v113
    v_fma_f32 v113, v53, 0, v113
    v_fma_f32 v113, v54, 0, v113
    v_fma_f32 v113, v55, 0, v113
    v_cmp_lt_f32 s[96:97], v56, v112
    v_cmp_gt_f32 vcc, v56, v114
    v_mov_b32 v57, v16
    s_and_b64 s[96:97], s[96:97], vcc
    v_fma_f32 v113, v64, 0, v113
    v_fma_f32 v113, v65, 0, v113
    v_fma_f32 v113, v66, 0, v113
    v_fma_f32 v113, v67, 0, v113
    v_fma_f32 v113, v68, 0, v113
    v_fma_f32 v113, v69, 0, v113
    v_fma_f32 v113, v70, 0, v113
    v_fma_f32 v113, v71, 0, v113
    v_cmp_lt_f32 s[50:51], v72, v112
    v_cmp_gt_f32 vcc, v72, v114
    v_mov_b32 v73, v32
    s_and_b64 s[50:51], s[50:51], vcc
    v_cmp_o_f32 vcc, v113, v113
    s_and_b64 s[96:97], s[96:97], s[50:51]
    s_and_b64 s[96:97], s[96:97], vcc
    s_or_b64 s[96:97], s[96:97], s[94:95]
    s_cmp_eq_u64 s[96:97], -1
    s_cbranch_scc0 A_FBS_G
    s_setprio 3
    s_mul_i32 s47, s44, 5120
    s_add_u32 s47, s47, 77824
    v_add_u32 v8, s47, v2
    v_lshlrev_b32 v9, 3, v1
    v_add_u32 v9, s47, v9
    ds_write_b128 v8, v[48:51] offset:0
    ds_write_b128 v8, v[52:55] offset:1024
    ds_write_b64 v9, v[56:57] offset:2048
    ds_write_b128 v8, v[64:67] offset:2560
    ds_write_b128 v8, v[68:71] offset:3584
    ds_write_b64 v9, v[72:73] offset:4608
    s_lshl_b32 s47, s44, 2
    s_add_u32 s47, s47, 65552
    v_mov_b32 v14, s47
    v_mov_b32 v15, 1
    ds_write_b32 v14, v15
    v_lshlrev_b32 v10, 2, v4
    v_sub_u32 v10, v5, v10
    v_add_u32 v10, 18, v10
    v_mov_b32 v12, 0x5555
    v_mov_b32 v13, 0
    v_lshlrev_b64 v[12:13], v10, v[12:13]
    v_not_b32 v12, v12
    v_not_b32 v13, v13
    s_cmp_eq_u32 s10, 0
    s_cselect_b32 s47, -1, 0
    v_or_b32 v12, s47, v12
    s_mov_b32 s47, 0xf149f2ca
    v_bfe_i32 v80, v13, 0, 1
    v_and_b32 v80, s47, v80
    v_bfe_i32 v81, v13, 1, 1
    v_and_b32 v81, s47, v81
    v_bfe_i32 v82, v13, 2, 1
    v_and_b32 v82, s47, v82
    v_bfe_i32 v83, v13, 3, 1
    v_and_b32 v83, s47, v83
    v_bfe_i32 v84, v13, 8, 1
    v_and_b32 v84, s47, v84
    v_bfe_i32 v85, v13, 9, 1
    v_and_b32 v85, s47, v85
    v_bfe_i32 v86, v13, 10, 1
    v_and_b32 v86, s47, v86
    v_bfe_i32 v87, v13, 11, 1
    v_and_b32 v87, s47, v87
    v_bfe_i32 v88, v13, 16, 1
    v_and_b32 v88, s47, v88
    v_bfe_i32 v89, v13, 17, 1
    v_and_b32 v89, s47, v89
    v_bfe_i32 v90, v13, 18, 1
    v_and_b32 v90, s47, v90
    v_bfe_i32 v91, v13, 19, 1
    v_and_b32 v91, s47, v91
    v_bfe_i32 v92, v13, 24, 1
    v_and_b32 v92, s47, v92
    v_bfe_i32 v93, v13, 25, 1
    v_and_b32 v93, s47, v93
    v_bfe_i32 v94, v13, 26, 1
    v_and_b32 v94, s47, v94
    v_bfe_i32 v95, v13, 27, 1
    v_and_b32 v95, s47, v95
    s_nop 1
    v_mfma_f32_32x32x16_bf16 v[144:159], v[240:243], v[232:235], v[80:95]
    v_mfma_f32_32x32x16_bf16 v[176:191], v[244:247], v[236:239], v[80:95]
    v_bfe_i32 v104, v12, 16, 1
    v_and_b32 v104, s47, v104
    v_bfe_i32 v105, v12, 17, 1
    v_and_b32 v105, s47, v105
    v_bfe_i32 v106, v12, 18, 1
    v_and_b32 v106, s47, v106
    v_bfe_i32 v107, v12, 19, 1
    v_and_b32 v107, s47, v107
    v_bfe_i32 v108, v12, 24, 1
    v_and_b32 v108, s47, v108
    v_bfe_i32 v109, v12, 25, 1
    v_and_b32 v109, s47, v109
    v_bfe_i32 v110, v12, 26, 1
    v_and_b32 v110, s47, v110
    v_bfe_i32 v111, v12, 27, 1
    v_and_b32 v111, s47, v111
    v_mov_b32 v140, 0x3f803f80
    v_mov_b32 v141, 0x3f803f80
    v_mov_b32 v142, 0x3f803f80
    v_mov_b32 v143, 0x3f803f80
    s_waitcnt vmcnt(0)
    v_mfma_f32_32x32x16_bf16 v[160:175], v[128:131], v[232:235], v[96:111]
    v_mfma_f32_32x32x16_bf16 v[192:207], v[132:135], v[236:239], v[96:111]
    v_cmp_ne_u32 vcc, s76, v229
    s_cbranch_vccnz POLL10_S
POLLD10:
    v_lshlrev_b32 v228, 16, v228
    s_lshl_b32 s80, s10, 6
    s_lshl_b32 s47, s11, 1
    s_add_u32 s80, s80, s47
    s_add_u32 s80, s80, 32
    s_lshl_b32 s80, s80, 10
    s_add_u32 s80, s80, 0xc00000
    s_lshl_b32 s81, s10, 4
    s_add_u32 s81, s81, s11
    s_lshl_b32 s81, s81, 7
    s_add_u32 s81, s81, 0x1060000
    s_waitcnt lgkmcnt(0)
    v_max3_f32 v10, v144, v145, v146
    v_max3_f32 v10, v10, v147, v148
    v_max3_f32 v10, v10, v149, v150
    v_max3_f32 v10, v10, v151, v152
    v_max3_f32 v10, v10, v153, v154
    v_max3_f32 v10, v10, v155, v156
    v_max3_f32 v10, v10, v157, v158
    v_max3_f32 v10, v10, v159, v168
    v_max3_f32 v10, v10, v169, v170
    v_max3_f32 v10, v10, v171, v172
    v_max3_f32 v10, v10, v173, v174
    v_max_f32 v10, v10, v175
    v_mov_b32 v11, v10
    s_nop 1
    v_permlane32_swap_b32 v10, v11
    s_nop 1
    v_max_f32 v10, v10, v11
    v_sub_f32 v144, v144, v10
    v_sub_f32 v145, v145, v10
    v_sub_f32 v146, v146, v10
    v_sub_f32 v147, v147, v10
    v_sub_f32 v148, v148, v10
    v_sub_f32 v149, v149, v10
    v_sub_f32 v150, v150, v10
    v_sub_f32 v151, v151, v10
    v_sub_f32 v152, v152, v10
    v_sub_f32 v153, v153, v10
    v_sub_f32 v154, v154, v10
    v_sub_f32 v155, v155, v10
    v_sub_f32 v156, v156, v10
    v_sub_f32 v157, v157, v10
    v_sub_f32 v158, v158, v10
    v_sub_f32 v159, v159, v10
    v_sub_f32 v168, v168, v10
    v_sub_f32 v169, v169, v10
    v_sub_f32 v170, v170, v10
    v_sub_f32 v171, v171, v10
    v_sub_f32 v172, v172, v10
    v_sub_f32 v173, v173, v10
    v_sub_f32 v174, v174, v10
    v_sub_f32 v175, v175, v10
    v_exp_f32 v144, v144
    v_exp_f32 v145, v145
    v_exp_f32 v146, v146
    v_exp_f32 v147, v147
    v_exp_f32 v148, v148
    v_exp_f32 v149, v149
    v_exp_f32 v150, v150
    v_exp_f32 v151, v151
    v_exp_f32 v152, v152
    v_exp_f32 v153, v153
    v_exp_f32 v154, v154
    v_exp_f32 v155, v155
    v_exp_f32 v156, v156
    v_exp_f32 v157, v157
    v_exp_f32 v158, v158
    v_exp_f32 v159, v159
    v_exp_f32 v168, v168
    v_exp_f32 v169, v169
    v_exp_f32 v170, v170
    v_exp_f32 v171, v171
    v_exp_f32 v172, v172
    v_exp_f32 v173, v173
    v_exp_f32 v174, v174
    v_exp_f32 v175, v175
    s_nop 0
    v_cvt_pk_bf16_f32 v32, v144, v145
    v_cvt_pk_bf16_f32 v33, v146, v147
    v_cvt_pk_bf16_f32 v34, v148, v149
    v_cvt_pk_bf16_f32 v35, v150, v151
    v_cvt_pk_bf16_f32 v36, v152, v153
    v_cvt_pk_bf16_f32 v37, v154, v155
    v_cvt_pk_bf16_f32 v38, v156, v157
    v_cvt_pk_bf16_f32 v39, v158, v159
    v_cvt_pk_bf16_f32 v40, v168, v169
    v_cvt_pk_bf16_f32 v41, v170, v171
    v_cvt_pk_bf16_f32 v42, v172, v173
    v_cvt_pk_bf16_f32 v43, v174, v175
    s_nop 1
    v_mfma_f32_32x32x16_bf16 v[48:63], v[248:251], v[32:35], 0
    v_mfma_f32_32x32x16_bf16 v[48:63], v[252:255], v[36:39], v[48:63]
    v_mfma_f32_32x32x16_bf16 v[48:63], v[136:139], v[40:43], v[48:63]
    v_mfma_f32_32x32x16_bf16 v[80:95], v[140:143], v[32:35], 0
    v_mfma_f32_32x32x16_bf16 v[80:95], v[140:143], v[36:39], v[80:95]
    v_mfma_f32_32x32x16_bf16 v[80:95], v[140:143], v[40:43], v[80:95]
    v_max3_f32 v10, v176, v177, v178
    v_max3_f32 v10, v10, v179, v180
    v_max3_f32 v10, v10, v181, v182
    v_max3_f32 v10, v10, v183, v184
    v_max3_f32 v10, v10, v185, v186
    v_max3_f32 v10, v10, v187, v188
    v_max3_f32 v10, v10, v189, v190
    v_max3_f32 v10, v10, v191, v200
    v_max3_f32 v10, v10, v201, v202
    v_max3_f32 v10, v10, v203, v204
    v_max3_f32 v10, v10, v205, v206
    v_max_f32 v10, v10, v207
    v_mov_b32 v11, v10
    s_nop 1
    v_permlane32_swap_b32 v10, v11
    s_nop 1
    v_max_f32 v10, v10, v11
    v_sub_f32 v176, v176, v10
    v_sub_f32 v177, v177, v10
    v_sub_f32 v178, v178, v10
    v_sub_f32 v179, v179, v10
    v_sub_f32 v180, v180, v10
    v_sub_f32 v181, v181, v10
    v_sub_f32 v182, v182, v10
    v_sub_f32 v183, v183, v10
    v_sub_f32 v184, v184, v10
    v_sub_f32 v185, v185, v10
    v_sub_f32 v186, v186, v10
    v_sub_f32 v187, v187, v10
    v_sub_f32 v188, v188, v10
    v_sub_f32 v189, v189, v10
    v_sub_f32 v190, v190, v10
    v_sub_f32 v191, v191, v10
    v_sub_f32 v200, v200, v10
    v_sub_f32 v201, v201, v10
    v_sub_f32 v202, v202, v10
    v_sub_f32 v203, v203, v10
    v_sub_f32 v204, v204, v10
    v_sub_f32 v205, v205, v10
    v_sub_f32 v206, v206, v10
    v_sub_f32 v207, v207, v10
    v_exp_f32 v176, v176
    v_exp_f32 v177, v177
    v_exp_f32 v178, v178
    v_exp_f32 v179, v179
    v_exp_f32 v180, v180
    v_exp_f32 v181, v181
    v_exp_f32 v182, v182
    v_exp_f32 v183, v183
    v_exp_f32 v184, v184
    v_exp_f32 v185, v185
    v_exp_f32 v186, v186
    v_exp_f32 v187, v187
    v_exp_f32 v188, v188
    v_exp_f32 v189, v189
    v_exp_f32 v190, v190
    v_exp_f32 v191, v191
    v_exp_f32 v200, v200
    v_exp_f32 v201, v201
    v_exp_f32 v202, v202
    v_exp_f32 v203, v203
    v_exp_f32 v204, v204
    v_exp_f32 v205, v205
    v_exp_f32 v206, v206
    v_exp_f32 v207, v207
    s_nop 0
    v_cvt_pk_bf16_f32 v112, v176, v177
    v_cvt_pk_bf16_f32 v113, v178, v179
    v_cvt_pk_bf16_f32 v114, v180, v181
    v_cvt_pk_bf16_f32 v115, v182, v183
    v_cvt_pk_bf16_f32 v116, v184, v185
    v_cvt_pk_bf16_f32 v117, v186, v187
    v_cvt_pk_bf16_f32 v118, v188, v189
    v_cvt_pk_bf16_f32 v119, v190, v191
    v_cvt_pk_bf16_f32 v120, v200, v201
    v_cvt_pk_bf16_f32 v121, v202, v203
    v_cvt_pk_bf16_f32 v122, v204, v205
    v_cvt_pk_bf16_f32 v123, v206, v207
    s_nop 1
    v_mfma_f32_32x32x16_bf16 v[64:79], v[248:251], v[112:115], 0
    v_mfma_f32_32x32x16_bf16 v[64:79], v[252:255], v[116:119], v[64:79]
    v_mfma_f32_32x32x16_bf16 v[64:79], v[136:139], v[120:123], v[64:79]
    v_mfma_f32_32x32x16_bf16 v[96:111], v[140:143], v[112:115], 0
    v_mfma_f32_32x32x16_bf16 v[96:111], v[140:143], v[116:119], v[96:111]
    v_mfma_f32_32x32x16_bf16 v[96:111], v[140:143], v[120:123], v[96:111]
    v_rcp_f32 v10, v80
    s_nop 0
    v_mul_f32 v10, v10, v228
    v_mul_f32 v48, v10, v48
    v_mul_f32 v49, v10, v49
    v_mul_f32 v50, v10, v50
    v_mul_f32 v51, v10, v51
    v_mul_f32 v52, v10, v52
    v_mul_f32 v53, v10, v53
    v_mul_f32 v54, v10, v54
    v_mul_f32 v55, v10, v55
    v_cvt_pk_bf16_f32 v208, v48, v49
    v_cvt_pk_bf16_f32 v209, v50, v51
    v_cvt_pk_bf16_f32 v210, v52, v53
    v_cvt_pk_bf16_f32 v211, v54, v55
    buffer_store_dwordx4 v[208:211], v2, s[28:31], s80 offen offset:0 sc1
    v_rcp_f32 v10, v96
    s_nop 0
    v_mul_f32 v10, v10, v228
    v_mul_f32 v72, v10, v72
    v_mul_f32 v73, v10, v73
    v_mul_f32 v74, v10, v74
    v_mul_f32 v75, v10, v75
    v_mul_f32 v76, v10, v76
    v_mul_f32 v77, v10, v77
    v_mul_f32 v78, v10, v78
    v_mul_f32 v79, v10, v79
    v_cvt_pk_bf16_f32 v212, v72, v73
    v_cvt_pk_bf16_f32 v213, v74, v75
    v_cvt_pk_bf16_f32 v214, v76, v77
    v_cvt_pk_bf16_f32 v215, v78, v79
    buffer_store_dwordx4 v[212:215], v2, s[28:31], s80 offen offset:1024 sc1
    v_bfe_u32 v232, v1, 2, 2
    v_lshl_add_u32 v233, v4, 2, v232
    v_lshlrev_b32 v233, 7, v233
    v_and_b32 v234, 1, v1
    v_lshlrev_b32 v234, 2, v234
    v_bfe_u32 v235, v1, 1, 1
    v_add_u32 v234, v234, v235
    v_bfe_u32 v235, v1, 4, 1
    v_lshl_add_u32 v234, v235, 1, v234
    s_and_b32 s47, s65, 1
    s_lshl_b32 s47, s47, 1
    v_xor_b32 v234, s47, v234
    v_and_b32 v235, 1, v234
    v_lshl_add_u32 v233, v235, 3, v233
    v_lshrrev_b32 v234, 1, v234
    v_bfe_u32 v235, v1, 3, 1
    s_lshr_b32 s47, s65, 1
    v_xor_b32 v235, s47, v235
    v_lshl_add_u32 v234, v235, 2, v234
    v_lshl_add_u32 v233, v234, 4, v233
    s_lshl_b32 s47, s65, 14
    v_add_u32 v232, s47, v233
    v_xor_b32 v233, 64, v232
    v_add_u32 v234, 98304, v232
    v_add_u32 v235, 98304, v233
    v_and_b32 v224, 3, v1
    v_lshlrev_b32 v224, 7, v224
    s_waitcnt vmcnt(0)
    v_mov_b32 v12, s76
    v_mov_b32 v13, s77
    v_mov_b32 v14, 0
    s_mov_b64 exec, 1
    buffer_store_dwordx2 v[12:13], v14, s[28:31], s81 offen sc1
    s_mov_b64 exec, -1
    s_setprio 3
    s_mov_b32 s78, 0
POLL11:
    s_sleep 4
    buffer_load_dwordx2 v[244:245], v224, s[28:31], s69 offen sc1
    s_add_u32 s78, s78, 1
    s_cmp_lt_u32 s78, 65536
    s_cselect_b64 s[96:97], -1, 0
    s_waitcnt vmcnt(0)
    v_cmp_ne_u64 vcc, s[76:77], v[244:245]
    s_nop 0
    s_and_b64 s[96:97], vcc, s[96:97]
    s_cbranch_scc1 POLL11
    buffer_load_dwordx4 v[152:155], v2, s[28:31], s68 offen offset:0 sc1
    buffer_load_dwordx4 v[156:159], v2, s[28:31], s68 offen offset:1024 sc1
    buffer_load_dwordx4 v[160:163], v2, s[28:31], s68 offen offset:2048 sc1
    buffer_load_dwordx4 v[164:167], v2, s[28:31], s68 offen offset:3072 sc1
    buffer_load_dwordx4 v[168:171], v2, s[28:31], s71 offen offset:0 sc1
    buffer_load_dwordx4 v[172:175], v2, s[28:31], s71 offen offset:1024 sc1
    buffer_load_dwordx4 v[176:179], v2, s[28:31], s71 offen offset:2048 sc1
    buffer_load_dwordx4 v[180:183], v2, s[28:31], s71 offen offset:3072 sc1
    s_waitcnt vmcnt(0)
    s_setprio 3
PHASE3:
    s_barrier
    ds_read_b64_tr_b16 v[184:185], v234 offset:0
    ds_read_b64_tr_b16 v[186:187], v234 offset:1024
    ds_read_b64_tr_b16 v[188:189], v235 offset:0
    ds_read_b64_tr_b16 v[190:191], v235 offset:1024
    ds_read_b64_tr_b16 v[192:193], v234 offset:2048
    ds_read_b64_tr_b16 v[194:195], v234 offset:3072
    ds_read_b64_tr_b16 v[196:197], v235 offset:2048
    ds_read_b64_tr_b16 v[198:199], v235 offset:3072
    ds_read_b64_tr_b16 v[200:201], v234 offset:4096
    ds_read_b64_tr_b16 v[202:203], v234 offset:5120
    ds_read_b64_tr_b16 v[204:205], v235 offset:4096
    ds_read_b64_tr_b16 v[206:207], v235 offset:5120
    s_waitcnt lgkmcnt(8)
    v_mfma_f32_32x32x16_bf16 v[48:63], v[184:187], v[152:155], 0
    v_mfma_f32_32x32x16_bf16 v[64:79], v[188:191], v[152:155], 0
    ds_read_b64_tr_b16 v[208:209], v234 offset:6144
    ds_read_b64_tr_b16 v[210:211], v234 offset:7168
    ds_read_b64_tr_b16 v[212:213], v235 offset:6144
    ds_read_b64_tr_b16 v[214:215], v235 offset:7168
    s_waitcnt lgkmcnt(8)
    v_mfma_f32_32x32x16_bf16 v[48:63], v[192:195], v[156:159], v[48:63]
    v_mfma_f32_32x32x16_bf16 v[64:79], v[196:199], v[156:159], v[64:79]
    ds_read_b64_tr_b16 v[184:185], v234 offset:8192
    ds_read_b64_tr_b16 v[186:187], v234 offset:9216
    ds_read_b64_tr_b16 v[188:189], v235 offset:8192
    ds_read_b64_tr_b16 v[190:191], v235 offset:9216
    s_waitcnt lgkmcnt(8)
    v_mfma_f32_32x32x16_bf16 v[48:63], v[200:203], v[160:163], v[48:63]
    v_mfma_f32_32x32x16_bf16 v[64:79], v[204:207], v[160:163], v[64:79]
    ds_read_b64_tr_b16 v[192:193], v234 offset:10240
    ds_read_b64_tr_b16 v[194:195], v234 offset:11264
    ds_read_b64_tr_b16 v[196:197], v235 offset:10240
    ds_read_b64_tr_b16 v[198:199], v235 offset:11264
    s_waitcnt lgkmcnt(8)
    v_mfma_f32_32x32x16_bf16 v[48:63], v[208:211], v[164:167], v[48:63]
    v_mfma_f32_32x32x16_bf16 v[64:79], v[212:215], v[164:167], v[64:79]
    ds_read_b64_tr_b16 v[200:201], v234 offset:12288
    ds_read_b64_tr_b16 v[202:203], v234 offset:13312
    ds_read_b64_tr_b16 v[204:205], v235 offset:12288
    ds_read_b64_tr_b16 v[206:207], v235 offset:13312
    s_waitcnt lgkmcnt(8)
    v_mfma_f32_32x32x16_bf16 v[48:63], v[184:187], v[168:171], v[48:63]
    v_mfma_f32_32x32x16_bf16 v[64:79], v[188:191], v[168:171], v[64:79]
    ds_read_b64_tr_b16 v[208:209], v234 offset:14336
    ds_read_b64_tr_b16 v[210:211], v234 offset:15360
    ds_read_b64_tr_b16 v[212:213], v235 offset:14336
    ds_read_b64_tr_b16 v[214:215], v235 offset:15360
    s_waitcnt lgkmcnt(8)
    v_mfma_f32_32x32x16_bf16 v[48:63], v[192:195], v[172:175], v[48:63]
    v_mfma_f32_32x32x16_bf16 v[64:79], v[196:199], v[172:175], v[64:79]
    s_waitcnt lgkmcnt(4)
    v_mfma_f32_32x32x16_bf16 v[48:63], v[200:203], v[176:179], v[48:63]
    v_mfma_f32_32x32x16_bf16 v[64:79], v[204:207], v[176:179], v[64:79]
    buffer_load_dwordx4 v[80:83], v2, s[28:31], s67 offen offset:0 sc1
    buffer_load_dwordx4 v[84:87], v2, s[28:31], s67 offen offset:1024 sc1
    buffer_load_dwordx4 v[88:91], v2, s[28:31], s67 offen offset:2048 sc1
    buffer_load_dwordx4 v[92:95], v2, s[28:31], s67 offen offset:3072 sc1
    buffer_load_dwordx4 v[96:99], v2, s[28:31], s70 offen offset:0 sc1
    buffer_load_dwordx4 v[100:103], v2, s[28:31], s70 offen offset:1024 sc1
    buffer_load_dwordx4 v[104:107], v2, s[28:31], s70 offen offset:2048 sc1
    buffer_load_dwordx4 v[108:111], v2, s[28:31], s70 offen offset:3072 sc1
    s_waitcnt lgkmcnt(0)
    v_mfma_f32_32x32x16_bf16 v[48:63], v[208:211], v[180:183], v[48:63]
    v_mfma_f32_32x32x16_bf16 v[64:79], v[212:215], v[180:183], v[64:79]
    s_barrier
    ds_read_b64_tr_b16 v[128:129], v232 offset:0
    ds_read_b64_tr_b16 v[130:131], v232 offset:1024
    ds_read_b64_tr_b16 v[132:133], v233 offset:0
    ds_read_b64_tr_b16 v[134:135], v233 offset:1024
    ds_read_b64_tr_b16 v[136:137], v232 offset:2048
    ds_read_b64_tr_b16 v[138:139], v232 offset:3072
    ds_read_b64_tr_b16 v[140:141], v233 offset:2048
    ds_read_b64_tr_b16 v[142:143], v233 offset:3072
    ds_read_b64_tr_b16 v[144:145], v232 offset:4096
    ds_read_b64_tr_b16 v[146:147], v232 offset:5120
    ds_read_b64_tr_b16 v[148:149], v233 offset:4096
    ds_read_b64_tr_b16 v[150:151], v233 offset:5120
    s_waitcnt lgkmcnt(8)
    ds_read_b64_tr_b16 v[152:153], v232 offset:6144
    ds_read_b64_tr_b16 v[154:155], v232 offset:7168
    ds_read_b64_tr_b16 v[156:157], v233 offset:6144
    ds_read_b64_tr_b16 v[158:159], v233 offset:7168
    s_waitcnt lgkmcnt(8)
    ds_read_b64_tr_b16 v[160:161], v232 offset:8192
    ds_read_b64_tr_b16 v[162:163], v232 offset:9216
    ds_read_b64_tr_b16 v[164:165], v233 offset:8192
    ds_read_b64_tr_b16 v[166:167], v233 offset:9216
    s_waitcnt lgkmcnt(8)
    ds_read_b64_tr_b16 v[168:169], v232 offset:10240
    ds_read_b64_tr_b16 v[170:171], v232 offset:11264
    ds_read_b64_tr_b16 v[172:173], v233 offset:10240
    ds_read_b64_tr_b16 v[174:175], v233 offset:11264
    s_waitcnt lgkmcnt(8)
    ds_read_b64_tr_b16 v[176:177], v232 offset:12288
    ds_read_b64_tr_b16 v[178:179], v232 offset:13312
    ds_read_b64_tr_b16 v[180:181], v233 offset:12288
    ds_read_b64_tr_b16 v[182:183], v233 offset:13312
    s_waitcnt lgkmcnt(8)
    ds_read_b64_tr_b16 v[184:185], v232 offset:14336
    ds_read_b64_tr_b16 v[186:187], v232 offset:15360
    ds_read_b64_tr_b16 v[188:189], v233 offset:14336
    ds_read_b64_tr_b16 v[190:191], v233 offset:15360
    s_mov_b32 s32, s18
    s_mov_b32 s33, s19
    s_mov_b32 s34, 0x200000
    s_mov_b32 s35, 0x20000
    s_xor_b32 s47, s63, 2
    s_mul_i32 s47, s47, 6144
    s_add_u32 s47, s47, 98304
    v_add_u32 v9, s47, v2
    s_xor_b32 s47, s63, 4
    s_mul_i32 s47, s47, 6144
    s_add_u32 s47, s47, 100352
    v_add_u32 v10, s47, v2
    s_xor_b32 s47, s63, 6
    s_mul_i32 s47, s47, 6144
    s_add_u32 s47, s47, 102400
    v_add_u32 v11, s47, v2
    s_mul_i32 s47, s63, 6144
    s_add_u32 s47, s47, 98304
    v_add_u32 v8, s47, v2
    v_lshlrev_b32 v12, 10, v5
    v_lshl_add_u32 v12, v4, 5, v12
    s_waitcnt lgkmcnt(0)
    s_waitcnt vmcnt(7)
    v_max3_u32 v13, v80, v81, v82
    v_max_u32 v13, v13, v83
    v_cmp_eq_u32 vcc, -1, v13
    s_cbranch_vccnz OA0_S
OA0_D:
    v_mfma_f32_32x32x16_bf16 v[48:63], v[128:131], v[80:83], v[48:63]
    v_mfma_f32_32x32x16_bf16 v[64:79], v[132:135], v[80:83], v[64:79]
    s_waitcnt vmcnt(6)
    v_max3_u32 v13, v84, v85, v86
    v_max_u32 v13, v13, v87
    v_cmp_eq_u32 vcc, -1, v13
    s_cbranch_vccnz OA1_S
OA1_D:
    v_mfma_f32_32x32x16_bf16 v[48:63], v[136:139], v[84:87], v[48:63]
    v_mfma_f32_32x32x16_bf16 v[64:79], v[140:143], v[84:87], v[64:79]
    s_waitcnt vmcnt(5)
    v_max3_u32 v13, v88, v89, v90
    v_max_u32 v13, v13, v91
    v_cmp_eq_u32 vcc, -1, v13
    s_cbranch_vccnz OA2_S
OA2_D:
    v_mfma_f32_32x32x16_bf16 v[48:63], v[144:147], v[88:91], v[48:63]
    v_mfma_f32_32x32x16_bf16 v[64:79], v[148:151], v[88:91], v[64:79]
    s_waitcnt vmcnt(4)
    v_max3_u32 v13, v92, v93, v94
    v_max_u32 v13, v13, v95
    v_cmp_eq_u32 vcc, -1, v13
    s_cbranch_vccnz OA3_S
OA3_D:
    v_mfma_f32_32x32x16_bf16 v[48:63], v[152:155], v[92:95], v[48:63]
    v_mfma_f32_32x32x16_bf16 v[64:79], v[156:159], v[92:95], v[64:79]
    s_waitcnt vmcnt(3)
    v_max3_u32 v13, v96, v97, v98
    v_max_u32 v13, v13, v99
    v_cmp_eq_u32 vcc, -1, v13
    s_cbranch_vccnz OA4_S
OA4_D:
    v_mfma_f32_32x32x16_bf16 v[48:63], v[160:163], v[96:99], v[48:63]
    v_mfma_f32_32x32x16_bf16 v[64:79], v[164:167], v[96:99], v[64:79]
    s_waitcnt vmcnt(2)
    v_max3_u32 v13, v100, v101, v102
    v_max_u32 v13, v13, v103
    v_cmp_eq_u32 vcc, -1, v13
    s_cbranch_vccnz OA5_S
OA5_D:
    v_mfma_f32_32x32x16_bf16 v[48:63], v[168:171], v[100:103], v[48:63]
    v_mfma_f32_32x32x16_bf16 v[64:79], v[172:175], v[100:103], v[64:79]
    s_waitcnt vmcnt(1)
    v_max3_u32 v13, v104, v105, v106
    v_max_u32 v13, v13, v107
    v_cmp_eq_u32 vcc, -1, v13
    s_cbranch_vccnz OA6_S
OA6_D:
    v_mfma_f32_32x32x16_bf16 v[48:63], v[176:179], v[104:107], v[48:63]
    v_mfma_f32_32x32x16_bf16 v[64:79], v[180:183], v[104:107], v[64:79]
    s_waitcnt vmcnt(0)
    v_max3_u32 v13, v108, v109, v110
    v_max_u32 v13, v13, v111
    v_cmp_eq_u32 vcc, -1, v13
    s_cbranch_vccnz OA7_S
OA7_D:
    v_mfma_f32_32x32x16_bf16 v[48:63], v[184:187], v[108:111], v[48:63]
    v_mfma_f32_32x32x16_bf16 v[64:79], v[188:191], v[108:111], v[64:79]
    s_nop 10
    ds_write_b128 v9, v[56:59]
    ds_write_b128 v9, v[60:63] offset:1024
    ds_write_b128 v10, v[64:67]
    ds_write_b128 v10, v[68:71] offset:1024
    ds_write_b128 v11, v[72:75]
    ds_write_b128 v11, v[76:79] offset:1024
    s_waitcnt lgkmcnt(0)
    s_barrier
    ds_read_b128 v[192:195], v8 offset:0
    ds_read_b128 v[196:199], v8 offset:1024
    ds_read_b128 v[200:203], v8 offset:2048
    ds_read_b128 v[204:207], v8 offset:3072
    ds_read_b128 v[208:211], v8 offset:4096
    ds_read_b128 v[212:215], v8 offset:5120
    s_waitcnt lgkmcnt(4)
    v_add_f32 v48, v48, v192
    v_add_f32 v49, v49, v193
    v_add_f32 v50, v50, v194
    v_add_f32 v51, v51, v195
    v_add_f32 v52, v52, v196
    v_add_f32 v53, v53, v197
    v_add_f32 v54, v54, v198
    v_add_f32 v55, v55, v199
    s_waitcnt lgkmcnt(2)
    v_add_f32 v48, v48, v200
    v_add_f32 v49, v49, v201
    v_add_f32 v50, v50, v202
    v_add_f32 v51, v51, v203
    v_add_f32 v52, v52, v204
    v_add_f32 v53, v53, v205
    v_add_f32 v54, v54, v206
    v_add_f32 v55, v55, v207
    s_waitcnt lgkmcnt(0)
    v_add_f32 v48, v48, v208
    v_add_f32 v49, v49, v209
    v_add_f32 v50, v50, v210
    v_add_f32 v51, v51, v211
    v_add_f32 v52, v52, v212
    v_add_f32 v53, v53, v213
    v_add_f32 v54, v54, v214
    v_add_f32 v55, v55, v215
    v_cvt_pk_bf16_f32 v112, v48, v49
    v_cvt_pk_bf16_f32 v113, v50, v51
    v_cvt_pk_bf16_f32 v114, v52, v53
    v_cvt_pk_bf16_f32 v115, v54, v55
    buffer_store_dwordx4 v[112:115], v12, s[32:35], s72 offen
K_END:
    s_endpgm
TAGPUB:
    s_or_b32 s76, s76, 1
    v_mov_b32 v28, s76
    v_mov_b32 v29, s77
    s_mov_b64 exec, 1
    buffer_store_dwordx2 v[28:29], v31, s[32:35], 0 offen sc1
    s_mov_b64 exec, -1
    s_branch TAGPUBD
TAG1_S:
    s_mov_b32 s78, 0
TAG1:
    s_sleep 2
    buffer_load_dwordx2 v[58:59], v31, s[32:35], 0 offen sc1
    s_waitcnt vmcnt(0)
    v_readfirstlane_b32 s76, v58
    v_readfirstlane_b32 s77, v59
    s_nop 1
    s_cmp_lg_u32 s76, 0
    s_cbranch_scc1 TAGD1
    s_add_u32 s78, s78, 1
    s_cmp_lt_u32 s78, 65536
    s_cbranch_scc1 TAG1
    s_branch TAGD1
LC3_S:
    s_mov_b32 s78, 0
LC3:
    s_sleep 2
    ds_read_b32 v243, v246
    s_waitcnt lgkmcnt(0)
    v_cmp_gt_u32 vcc, 4, v243
    s_cbranch_vccz LCD3
    s_add_u32 s78, s78, 1
    s_cmp_lt_u32 s78, 1048576
    s_cbranch_scc1 LC3
    s_branch LCD3
LC4_S:
    s_mov_b32 s78, 0
LC4:
    s_sleep 2
    ds_read_b32 v243, v246
    s_waitcnt lgkmcnt(0)
    v_cmp_gt_u32 vcc, 8, v243
    s_cbranch_vccz LCD4
    s_add_u32 s78, s78, 1
    s_cmp_lt_u32 s78, 1048576
    s_cbranch_scc1 LC4
    s_branch LCD4
LC5_S:
    s_mov_b32 s78, 0
LC5:
    s_sleep 2
    ds_read_b32 v243, v242
    s_waitcnt lgkmcnt(0)
    v_cmp_gt_u32 vcc, 1, v243
    s_cbranch_vccz LCD5
    s_add_u32 s78, s78, 1
    s_cmp_lt_u32 s78, 1048576
    s_cbranch_scc1 LC5
    s_branch LCD5
A_FBS_L:
    s_waitcnt vmcnt(0) lgkmcnt(0)
    v_mov_b32 v80, 0xf149f2ca
    v_mov_b32 v81, 0xf149f2ca
    s_mov_b32 s54, s52
    s_mov_b32 s50, 0
A_FB_L:
    buffer_load_dwordx4 v[128:131], v6, s[28:31], s54 offen sc1
    s_waitcnt vmcnt(0)
    v_mfma_f32_32x32x16_bf16 v[48:63], v[128:131], v[8:11], 0
    v_mfma_f32_32x32x16_bf16 v[64:79], v[128:131], v[12:15], 0
    s_nop 11
    v_max3_f32 v80, v80, v48, v49
    v_max3_f32 v80, v80, v50, v51
    v_max3_f32 v80, v80, v52, v53
    v_max3_f32 v80, v80, v54, v55
    v_max3_f32 v80, v80, v56, v57
    v_max3_f32 v80, v80, v58, v59
    v_max3_f32 v80, v80, v60, v61
    v_max3_f32 v80, v80, v62, v63
    v_max3_f32 v81, v81, v64, v65
    v_max3_f32 v81, v81, v66, v67
    v_max3_f32 v81, v81, v68, v69
    v_max3_f32 v81, v81, v70, v71
    v_max3_f32 v81, v81, v72, v73
    v_max3_f32 v81, v81, v74, v75
    v_max3_f32 v81, v81, v76, v77
    v_max3_f32 v81, v81, v78, v79
    s_add_u32 s54, s54, 2048
    s_add_u32 s50, s50, 1
    s_cmp_lt_u32 s50, 32
    s_cbranch_scc1 A_FB_L
    v_mov_b32 v82, v80
    s_nop 1
    v_permlane32_swap_b32 v82, v80
    s_nop 1
    v_max_f32 v82, v82, v80
    v_sub_f32 v16, 0, v82
    v_sub_f32 v17, 0, v82
    v_sub_f32 v18, 0, v82
    v_sub_f32 v19, 0, v82
    v_sub_f32 v20, 0, v82
    v_sub_f32 v21, 0, v82
    v_sub_f32 v22, 0, v82
    v_sub_f32 v23, 0, v82
    v_sub_f32 v24, 0, v82
    v_sub_f32 v25, 0, v82
    v_sub_f32 v26, 0, v82
    v_sub_f32 v27, 0, v82
    v_sub_f32 v28, 0, v82
    v_sub_f32 v29, 0, v82
    v_sub_f32 v30, 0, v82
    v_sub_f32 v31, 0, v82
    v_mov_b32 v82, v81
    s_nop 1
    v_permlane32_swap_b32 v82, v81
    s_nop 1
    v_max_f32 v82, v82, v81
    v_sub_f32 v32, 0, v82
    v_sub_f32 v33, 0, v82
    v_sub_f32 v34, 0, v82
    v_sub_f32 v35, 0, v82
    v_sub_f32 v36, 0, v82
    v_sub_f32 v37, 0, v82
    v_sub_f32 v38, 0, v82
    v_sub_f32 v39, 0, v82
    v_sub_f32 v40, 0, v82
    v_sub_f32 v41, 0, v82
    v_sub_f32 v42, 0, v82
    v_sub_f32 v43, 0, v82
    v_sub_f32 v44, 0, v82
    v_sub_f32 v45, 0, v82
    v_sub_f32 v46, 0, v82
    v_sub_f32 v47, 0, v82
    v_mov_b32 v132, v227
    v_mov_b32 v133, v227
    v_mov_b32 v134, v227
    v_mov_b32 v135, v227
    v_mov_b32 v136, v227
    v_mov_b32 v137, v227
    v_mov_b32 v138, v227
    v_mov_b32 v139, v227
    v_mov_b32 v144, v227
    v_mov_b32 v145, v227
    v_mov_b32 v146, v227
    v_mov_b32 v147, v227
    v_mov_b32 v148, v227
    v_mov_b32 v149, v227
    v_mov_b32 v150, v227
    v_mov_b32 v151, v227
    v_mov_b32 v156, v227
    v_mov_b32 v157, v227
    v_mov_b32 v158, v227
    v_mov_b32 v159, v227
    v_mov_b32 v160, v227
    v_mov_b32 v161, v227
    v_mov_b32 v162, v227
    v_mov_b32 v163, v227
    v_mov_b32 v168, v227
    v_mov_b32 v169, v227
    v_mov_b32 v170, v227
    v_mov_b32 v171, v227
    v_mov_b32 v172, v227
    v_mov_b32 v173, v227
    v_mov_b32 v174, v227
    v_mov_b32 v175, v227
    v_mov_b32 v180, v227
    v_mov_b32 v181, v227
    v_mov_b32 v182, v227
    v_mov_b32 v183, v227
    v_mov_b32 v184, v227
    v_mov_b32 v185, v227
    v_mov_b32 v186, v227
    v_mov_b32 v187, v227
    v_mov_b32 v192, v227
    v_mov_b32 v193, v227
    v_mov_b32 v194, v227
    v_mov_b32 v195, v227
    v_mov_b32 v196, v227
    v_mov_b32 v197, v227
    v_mov_b32 v198, v227
    v_mov_b32 v199, v227
    v_mov_b32 v204, v227
    v_mov_b32 v205, v227
    v_mov_b32 v206, v227
    v_mov_b32 v207, v227
    v_mov_b32 v208, v227
    v_mov_b32 v209, v227
    v_mov_b32 v210, v227
    v_mov_b32 v211, v227
    v_mov_b32 v216, v227
    v_mov_b32 v217, v227
    v_mov_b32 v218, v227
    v_mov_b32 v219, v227
    v_mov_b32 v220, v227
    v_mov_b32 v221, v227
    v_mov_b32 v222, v227
    v_mov_b32 v223, v227
    s_mov_b64 s[94:95], -1
    s_mov_b32 s54, s52
    s_mov_b32 s56, 0
    s_mov_b32 s26, 0
    buffer_load_dwordx4 v[128:131], v6, s[28:31], s54 offen offset:0 sc1
    buffer_load_dwordx4 v[140:143], v6, s[28:31], s54 offen offset:2048 sc1
    s_mov_b64 exec, s[60:61]
    buffer_load_dwordx4 v[132:135], v3, s[28:31], s54 offen offset:1024 sc1
    buffer_load_dwordx4 v[136:139], v3, s[28:31], s54 offen offset:1536 sc1
    buffer_load_dwordx4 v[144:147], v3, s[28:31], s54 offen offset:3072 sc1
    buffer_load_dwordx4 v[148:151], v3, s[28:31], s54 offen offset:3584 sc1
    s_mov_b64 exec, -1
    s_add_u32 s54, s54, 4096
    buffer_load_dwordx4 v[152:155], v6, s[28:31], s54 offen offset:0 sc1
    buffer_load_dwordx4 v[164:167], v6, s[28:31], s54 offen offset:2048 sc1
    s_mov_b64 exec, s[60:61]
    buffer_load_dwordx4 v[156:159], v3, s[28:31], s54 offen offset:1024 sc1
    buffer_load_dwordx4 v[160:163], v3, s[28:31], s54 offen offset:1536 sc1
    buffer_load_dwordx4 v[168:171], v3, s[28:31], s54 offen offset:3072 sc1
    buffer_load_dwordx4 v[172:175], v3, s[28:31], s54 offen offset:3584 sc1
    s_mov_b64 exec, -1
    s_add_u32 s54, s54, 4096
    buffer_load_dwordx4 v[176:179], v6, s[28:31], s54 offen offset:0 sc1
    buffer_load_dwordx4 v[188:191], v6, s[28:31], s54 offen offset:2048 sc1
    s_mov_b64 exec, s[60:61]
    buffer_load_dwordx4 v[180:183], v3, s[28:31], s54 offen offset:1024 sc1
    buffer_load_dwordx4 v[184:187], v3, s[28:31], s54 offen offset:1536 sc1
    buffer_load_dwordx4 v[192:195], v3, s[28:31], s54 offen offset:3072 sc1
    buffer_load_dwordx4 v[196:199], v3, s[28:31], s54 offen offset:3584 sc1
    s_mov_b64 exec, -1
    s_add_u32 s54, s54, 4096
    s_waitcnt vmcnt(0)
    s_branch A_MAIN_L
LGATE_S:
    s_mov_b32 s78, 0
LGATE:
    buffer_load_dwordx2 v[228:229], v225, s[28:31], s74 offen sc1
    buffer_load_dwordx2 v[230:231], v225, s[28:31], s74 offen offset:256 sc1
    s_waitcnt vmcnt(0)
    v_cmp_ne_u32 vcc, s76, v229
    v_cmp_ne_u32 s[96:97], s76, v231
    s_nop 1
    s_or_b64 s[96:97], s[96:97], vcc
    s_cbranch_scc0 LGATE_D
    s_add_u32 s78, s78, 1
    s_cmp_lt_u32 s78, 65536
    s_cbranch_scc1 LGATE
    s_branch LGATE_D
LOB_LATE:
    s_mov_b32 s78, 0
LOB_L:
    buffer_load_dwordx2 v[244:245], v224, s[28:31], s69 offen sc1
    s_waitcnt vmcnt(0)
    v_cmp_ne_u64 vcc, s[76:77], v[244:245]
    s_cbranch_vccz LOB_D
    s_add_u32 s78, s78, 1
    s_cmp_lt_u32 s78, 65536
    s_cbranch_scc1 LOB_L
LOB_D:
    buffer_load_dwordx4 v[152:155], v2, s[28:31], s68 offen offset:0 sc1
    buffer_load_dwordx4 v[156:159], v2, s[28:31], s68 offen offset:1024 sc1
    buffer_load_dwordx4 v[160:163], v2, s[28:31], s68 offen offset:2048 sc1
    buffer_load_dwordx4 v[164:167], v2, s[28:31], s68 offen offset:3072 sc1
    buffer_load_dwordx4 v[168:171], v2, s[28:31], s71 offen offset:0 sc1
    buffer_load_dwordx4 v[172:175], v2, s[28:31], s71 offen offset:1024 sc1
    buffer_load_dwordx4 v[176:179], v2, s[28:31], s71 offen offset:2048 sc1
    buffer_load_dwordx4 v[180:183], v2, s[28:31], s71 offen offset:3072 sc1
    s_waitcnt vmcnt(0)
    s_branch PHASE3
TAG6_S:
    s_mov_b32 s78, 0
TAG6:
    s_sleep 2
    buffer_load_dwordx2 v[28:29], v31, s[32:35], 0 offen sc1
    s_waitcnt vmcnt(0)
    v_readfirstlane_b32 s76, v28
    v_readfirstlane_b32 s77, v29
    s_nop 1
    s_cmp_lg_u32 s76, 0
    s_cbranch_scc1 TAGD6
    s_add_u32 s78, s78, 1
    s_cmp_lt_u32 s78, 65536
    s_cbranch_scc1 TAG6
    s_branch TAGD6
POLL7_S:
    s_mov_b32 s78, 0
POLL7:
    buffer_load_dwordx2 v[18:19], v17, s[28:31], s48 offen sc1
    s_waitcnt vmcnt(0)
    v_cmp_ne_u64 vcc, s[76:77], v[18:19]
    s_cbranch_vccz POLLD7
    s_sleep 2
    s_add_u32 s78, s78, 1
    s_cmp_lt_u32 s78, 65536
    s_cbranch_scc1 POLL7
    s_branch POLLD7
LC8_S:
    s_mov_b32 s78, 0
LC8:
    s_sleep 2
    ds_read_b32 v228, v224
    s_waitcnt lgkmcnt(0)
    v_cmp_gt_u32 vcc, 4, v228
    s_cbranch_vccz LCD8
    s_add_u32 s78, s78, 1
    s_cmp_lt_u32 s78, 1048576
    s_cbranch_scc1 LC8
    s_branch LCD8
POLL9_S:
    s_mov_b32 s78, 0
POLL9:
    buffer_load_dwordx2 v[228:229], v230, s[28:31], s88 offen sc1
    s_waitcnt vmcnt(0)
    v_cmp_ne_u64 vcc, s[76:77], v[228:229]
    s_cbranch_vccz POLLD9
    s_sleep 2
    s_add_u32 s78, s78, 1
    s_cmp_lt_u32 s78, 65536
    s_cbranch_scc1 POLL9
    s_branch POLLD9
A_FBS_G:
    s_waitcnt vmcnt(0) lgkmcnt(0)
    v_mov_b32 v80, 0xf149f2ca
    v_mov_b32 v81, 0xf149f2ca
    s_mov_b32 s54, s52
    s_mov_b32 s50, 0
A_FB_G:
    buffer_load_dwordx4 v[128:131], v6, s[28:31], s54 offen sc1
    s_waitcnt vmcnt(0)
    v_mfma_f32_32x32x16_bf16 v[48:63], v[128:131], v[8:11], 0
    v_mfma_f32_32x32x16_bf16 v[64:79], v[128:131], v[12:15], 0
    s_nop 11
    v_max3_f32 v80, v80, v48, v49
    v_max3_f32 v80, v80, v50, v51
    v_max3_f32 v80, v80, v52, v53
    v_max3_f32 v80, v80, v54, v55
    v_max3_f32 v80, v80, v56, v57
    v_max3_f32 v80, v80, v58, v59
    v_max3_f32 v80, v80, v60, v61
    v_max3_f32 v80, v80, v62, v63
    v_max3_f32 v81, v81, v64, v65
    v_max3_f32 v81, v81, v66, v67
    v_max3_f32 v81, v81, v68, v69
    v_max3_f32 v81, v81, v70, v71
    v_max3_f32 v81, v81, v72, v73
    v_max3_f32 v81, v81, v74, v75
    v_max3_f32 v81, v81, v76, v77
    v_max3_f32 v81, v81, v78, v79
    s_add_u32 s54, s54, 2048
    s_add_u32 s50, s50, 1
    s_cmp_lt_u32 s50, 32
    s_cbranch_scc1 A_FB_G
    v_mov_b32 v82, v80
    s_nop 1
    v_permlane32_swap_b32 v82, v80
    s_nop 1
    v_max_f32 v82, v82, v80
    v_sub_f32 v16, 0, v82
    v_sub_f32 v17, 0, v82
    v_sub_f32 v18, 0, v82
    v_sub_f32 v19, 0, v82
    v_sub_f32 v20, 0, v82
    v_sub_f32 v21, 0, v82
    v_sub_f32 v22, 0, v82
    v_sub_f32 v23, 0, v82
    v_sub_f32 v24, 0, v82
    v_sub_f32 v25, 0, v82
    v_sub_f32 v26, 0, v82
    v_sub_f32 v27, 0, v82
    v_sub_f32 v28, 0, v82
    v_sub_f32 v29, 0, v82
    v_sub_f32 v30, 0, v82
    v_sub_f32 v31, 0, v82
    v_mov_b32 v82, v81
    s_nop 1
    v_permlane32_swap_b32 v82, v81
    s_nop 1
    v_max_f32 v82, v82, v81
    v_sub_f32 v32, 0, v82
    v_sub_f32 v33, 0, v82
    v_sub_f32 v34, 0, v82
    v_sub_f32 v35, 0, v82
    v_sub_f32 v36, 0, v82
    v_sub_f32 v37, 0, v82
    v_sub_f32 v38, 0, v82
    v_sub_f32 v39, 0, v82
    v_sub_f32 v40, 0, v82
    v_sub_f32 v41, 0, v82
    v_sub_f32 v42, 0, v82
    v_sub_f32 v43, 0, v82
    v_sub_f32 v44, 0, v82
    v_sub_f32 v45, 0, v82
    v_sub_f32 v46, 0, v82
    v_sub_f32 v47, 0, v82
    v_mov_b32 v132, v227
    v_mov_b32 v133, v227
    v_mov_b32 v134, v227
    v_mov_b32 v135, v227
    v_mov_b32 v136, v227
    v_mov_b32 v137, v227
    v_mov_b32 v138, v227
    v_mov_b32 v139, v227
    v_mov_b32 v144, v227
    v_mov_b32 v145, v227
    v_mov_b32 v146, v227
    v_mov_b32 v147, v227
    v_mov_b32 v148, v227
    v_mov_b32 v149, v227
    v_mov_b32 v150, v227
    v_mov_b32 v151, v227
    v_mov_b32 v156, v227
    v_mov_b32 v157, v227
    v_mov_b32 v158, v227
    v_mov_b32 v159, v227
    v_mov_b32 v160, v227
    v_mov_b32 v161, v227
    v_mov_b32 v162, v227
    v_mov_b32 v163, v227
    v_mov_b32 v168, v227
    v_mov_b32 v169, v227
    v_mov_b32 v170, v227
    v_mov_b32 v171, v227
    v_mov_b32 v172, v227
    v_mov_b32 v173, v227
    v_mov_b32 v174, v227
    v_mov_b32 v175, v227
    v_mov_b32 v180, v227
    v_mov_b32 v181, v227
    v_mov_b32 v182, v227
    v_mov_b32 v183, v227
    v_mov_b32 v184, v227
    v_mov_b32 v185, v227
    v_mov_b32 v186, v227
    v_mov_b32 v187, v227
    v_mov_b32 v192, v227
    v_mov_b32 v193, v227
    v_mov_b32 v194, v227
    v_mov_b32 v195, v227
    v_mov_b32 v196, v227
    v_mov_b32 v197, v227
    v_mov_b32 v198, v227
    v_mov_b32 v199, v227
    v_mov_b32 v204, v227
    v_mov_b32 v205, v227
    v_mov_b32 v206, v227
    v_mov_b32 v207, v227
    v_mov_b32 v208, v227
    v_mov_b32 v209, v227
    v_mov_b32 v210, v227
    v_mov_b32 v211, v227
    v_mov_b32 v216, v227
    v_mov_b32 v217, v227
    v_mov_b32 v218, v227
    v_mov_b32 v219, v227
    v_mov_b32 v220, v227
    v_mov_b32 v221, v227
    v_mov_b32 v222, v227
    v_mov_b32 v223, v227
    s_mov_b64 s[94:95], -1
    s_mov_b32 s54, s52
    s_mov_b32 s56, 0
    s_mov_b32 s26, 0
    buffer_load_dwordx4 v[128:131], v6, s[28:31], s54 offen offset:0 sc1
    buffer_load_dwordx4 v[140:143], v6, s[28:31], s54 offen offset:2048 sc1
    s_mov_b64 exec, s[60:61]
    buffer_load_dwordx4 v[132:135], v3, s[28:31], s54 offen offset:1024 sc1
    buffer_load_dwordx4 v[136:139], v3, s[28:31], s54 offen offset:1536 sc1
    buffer_load_dwordx4 v[144:147], v3, s[28:31], s54 offen offset:3072 sc1
    buffer_load_dwordx4 v[148:151], v3, s[28:31], s54 offen offset:3584 sc1
    s_mov_b64 exec, -1
    s_add_u32 s54, s54, 4096
    buffer_load_dwordx4 v[152:155], v6, s[28:31], s54 offen offset:0 sc1
    buffer_load_dwordx4 v[164:167], v6, s[28:31], s54 offen offset:2048 sc1
    s_mov_b64 exec, s[60:61]
    buffer_load_dwordx4 v[156:159], v3, s[28:31], s54 offen offset:1024 sc1
    buffer_load_dwordx4 v[160:163], v3, s[28:31], s54 offen offset:1536 sc1
    buffer_load_dwordx4 v[168:171], v3, s[28:31], s54 offen offset:3072 sc1
    buffer_load_dwordx4 v[172:175], v3, s[28:31], s54 offen offset:3584 sc1
    s_mov_b64 exec, -1
    s_add_u32 s54, s54, 4096
    buffer_load_dwordx4 v[176:179], v6, s[28:31], s54 offen offset:0 sc1
    buffer_load_dwordx4 v[188:191], v6, s[28:31], s54 offen offset:2048 sc1
    s_mov_b64 exec, s[60:61]
    buffer_load_dwordx4 v[180:183], v3, s[28:31], s54 offen offset:1024 sc1
    buffer_load_dwordx4 v[184:187], v3, s[28:31], s54 offen offset:1536 sc1
    buffer_load_dwordx4 v[192:195], v3, s[28:31], s54 offen offset:3072 sc1
    buffer_load_dwordx4 v[196:199], v3, s[28:31], s54 offen offset:3584 sc1
    s_mov_b64 exec, -1
    s_add_u32 s54, s54, 4096
    s_waitcnt vmcnt(0)
    s_branch A_MAIN_G
POLL10_S:
    s_mov_b32 s78, 0
POLL10:
    buffer_load_dwordx2 v[228:229], v225, s[28:31], s75 offen sc1
    s_waitcnt vmcnt(0)
    v_cmp_ne_u32 vcc, s76, v229
    s_cbranch_vccz POLLD10
    s_sleep 2
    s_add_u32 s78, s78, 1
    s_cmp_lt_u32 s78, 65536
    s_cbranch_scc1 POLL10
    s_branch POLLD10
OA0_S:
    s_mov_b32 s78, 0
OA0:
    buffer_load_dwordx4 v[80:83], v2, s[28:31], s67 offen offset:0 sc1
    buffer_load_dwordx4 v[84:87], v2, s[28:31], s67 offen offset:1024 sc1
    buffer_load_dwordx4 v[88:91], v2, s[28:31], s67 offen offset:2048 sc1
    buffer_load_dwordx4 v[92:95], v2, s[28:31], s67 offen offset:3072 sc1
    buffer_load_dwordx4 v[96:99], v2, s[28:31], s70 offen offset:0 sc1
    buffer_load_dwordx4 v[100:103], v2, s[28:31], s70 offen offset:1024 sc1
    buffer_load_dwordx4 v[104:107], v2, s[28:31], s70 offen offset:2048 sc1
    buffer_load_dwordx4 v[108:111], v2, s[28:31], s70 offen offset:3072 sc1
    s_waitcnt vmcnt(7)
    v_max3_u32 v13, v80, v81, v82
    v_max_u32 v13, v13, v83
    v_cmp_eq_u32 vcc, -1, v13
    s_cbranch_vccz OA0_D
    s_add_u32 s78, s78, 1
    s_cmp_lt_u32 s78, 65536
    s_cbranch_scc1 OA0
    s_branch OA0_D
OA1_S:
    s_mov_b32 s78, 0
OA1:
    buffer_load_dwordx4 v[84:87], v2, s[28:31], s67 offen offset:1024 sc1
    buffer_load_dwordx4 v[88:91], v2, s[28:31], s67 offen offset:2048 sc1
    buffer_load_dwordx4 v[92:95], v2, s[28:31], s67 offen offset:3072 sc1
    buffer_load_dwordx4 v[96:99], v2, s[28:31], s70 offen offset:0 sc1
    buffer_load_dwordx4 v[100:103], v2, s[28:31], s70 offen offset:1024 sc1
    buffer_load_dwordx4 v[104:107], v2, s[28:31], s70 offen offset:2048 sc1
    buffer_load_dwordx4 v[108:111], v2, s[28:31], s70 offen offset:3072 sc1
    s_waitcnt vmcnt(6)
    v_max3_u32 v13, v84, v85, v86
    v_max_u32 v13, v13, v87
    v_cmp_eq_u32 vcc, -1, v13
    s_cbranch_vccz OA1_D
    s_add_u32 s78, s78, 1
    s_cmp_lt_u32 s78, 65536
    s_cbranch_scc1 OA1
    s_branch OA1_D
OA2_S:
    s_mov_b32 s78, 0
OA2:
    buffer_load_dwordx4 v[88:91], v2, s[28:31], s67 offen offset:2048 sc1
    buffer_load_dwordx4 v[92:95], v2, s[28:31], s67 offen offset:3072 sc1
    buffer_load_dwordx4 v[96:99], v2, s[28:31], s70 offen offset:0 sc1
    buffer_load_dwordx4 v[100:103], v2, s[28:31], s70 offen offset:1024 sc1
    buffer_load_dwordx4 v[104:107], v2, s[28:31], s70 offen offset:2048 sc1
    buffer_load_dwordx4 v[108:111], v2, s[28:31], s70 offen offset:3072 sc1
    s_waitcnt vmcnt(5)
    v_max3_u32 v13, v88, v89, v90
    v_max_u32 v13, v13, v91
    v_cmp_eq_u32 vcc, -1, v13
    s_cbranch_vccz OA2_D
    s_add_u32 s78, s78, 1
    s_cmp_lt_u32 s78, 65536
    s_cbranch_scc1 OA2
    s_branch OA2_D
OA3_S:
    s_mov_b32 s78, 0
OA3:
    buffer_load_dwordx4 v[92:95], v2, s[28:31], s67 offen offset:3072 sc1
    buffer_load_dwordx4 v[96:99], v2, s[28:31], s70 offen offset:0 sc1
    buffer_load_dwordx4 v[100:103], v2, s[28:31], s70 offen offset:1024 sc1
    buffer_load_dwordx4 v[104:107], v2, s[28:31], s70 offen offset:2048 sc1
    buffer_load_dwordx4 v[108:111], v2, s[28:31], s70 offen offset:3072 sc1
    s_waitcnt vmcnt(4)
    v_max3_u32 v13, v92, v93, v94
    v_max_u32 v13, v13, v95
    v_cmp_eq_u32 vcc, -1, v13
    s_cbranch_vccz OA3_D
    s_add_u32 s78, s78, 1
    s_cmp_lt_u32 s78, 65536
    s_cbranch_scc1 OA3
    s_branch OA3_D
OA4_S:
    s_mov_b32 s78, 0
OA4:
    buffer_load_dwordx4 v[96:99], v2, s[28:31], s70 offen offset:0 sc1
    buffer_load_dwordx4 v[100:103], v2, s[28:31], s70 offen offset:1024 sc1
    buffer_load_dwordx4 v[104:107], v2, s[28:31], s70 offen offset:2048 sc1
    buffer_load_dwordx4 v[108:111], v2, s[28:31], s70 offen offset:3072 sc1
    s_waitcnt vmcnt(3)
    v_max3_u32 v13, v96, v97, v98
    v_max_u32 v13, v13, v99
    v_cmp_eq_u32 vcc, -1, v13
    s_cbranch_vccz OA4_D
    s_add_u32 s78, s78, 1
    s_cmp_lt_u32 s78, 65536
    s_cbranch_scc1 OA4
    s_branch OA4_D
OA5_S:
    s_mov_b32 s78, 0
OA5:
    buffer_load_dwordx4 v[100:103], v2, s[28:31], s70 offen offset:1024 sc1
    buffer_load_dwordx4 v[104:107], v2, s[28:31], s70 offen offset:2048 sc1
    buffer_load_dwordx4 v[108:111], v2, s[28:31], s70 offen offset:3072 sc1
    s_waitcnt vmcnt(2)
    v_max3_u32 v13, v100, v101, v102
    v_max_u32 v13, v13, v103
    v_cmp_eq_u32 vcc, -1, v13
    s_cbranch_vccz OA5_D
    s_add_u32 s78, s78, 1
    s_cmp_lt_u32 s78, 65536
    s_cbranch_scc1 OA5
    s_branch OA5_D
OA6_S:
    s_mov_b32 s78, 0
OA6:
    buffer_load_dwordx4 v[104:107], v2, s[28:31], s70 offen offset:2048 sc1
    buffer_load_dwordx4 v[108:111], v2, s[28:31], s70 offen offset:3072 sc1
    s_waitcnt vmcnt(1)
    v_max3_u32 v13, v104, v105, v106
    v_max_u32 v13, v13, v107
    v_cmp_eq_u32 vcc, -1, v13
    s_cbranch_vccz OA6_D
    s_add_u32 s78, s78, 1
    s_cmp_lt_u32 s78, 65536
    s_cbranch_scc1 OA6
    s_branch OA6_D
OA7_S:
    s_mov_b32 s78, 0
OA7:
    buffer_load_dwordx4 v[108:111], v2, s[28:31], s70 offen offset:3072 sc1
    s_waitcnt vmcnt(0)
    v_max3_u32 v13, v108, v109, v110
    v_max_u32 v13, v13, v111
    v_cmp_eq_u32 vcc, -1, v13
    s_cbranch_vccz OA7_D
    s_add_u32 s78, s78, 1
    s_cmp_lt_u32 s78, 65536
    s_cbranch_scc1 OA7
    s_branch OA7_D
K_LAST:
    s_endpgm
.section .rodata,"a"
.p2align 6
.amdhsa_kernel gated_mix__mha_block__sliding_local_dilated__prompt_kernel
  .amdhsa_next_free_vgpr 256
  .amdhsa_next_free_sgpr 102
  .amdhsa_accum_offset 256
  .amdhsa_group_segment_fixed_size 0
  .amdhsa_kernarg_size 80
  .amdhsa_user_sgpr_count 2
  .amdhsa_user_sgpr_kernarg_segment_ptr 1
  .amdhsa_system_sgpr_workgroup_id_x 1
.end_amdhsa_kernel
```
